```python
import torch

def _softmax(x, axis=-1):
    return torch.softmax(x, dim=axis)
def _gelu(x):
    return torch.nn.functional.gelu(x, approximate="tanh")
def _silu(x):
    return torch.nn.functional.silu(x)
def _sigmoid(x):
    return torch.sigmoid(x)
def _layernorm(x, axis=-1, eps=1e-5):
    m = x.mean(dim=axis, keepdim=True)
    v = x.var(dim=axis, keepdim=True, unbiased=False)
    return (x - m) / torch.sqrt(v + eps)
def _scatter_add(tgt, idx, src, axis=0):
    return tgt.clone().index_add_(axis, idx, src)
def _segment_sum(src, seg, n):
    out = torch.zeros((n,) + src.shape[1:], dtype=src.dtype)
    return out.index_add_(0, seg, src)
def _pad(x, pw):
    flat = tuple(v for pair in reversed(pw) for v in pair)
    return torch.nn.functional.pad(x, flat)

kernel_name = 'gated_mix__compressed_kv_cla__geglu_ffn__decode'

def setup_inputs():

    _w = (lambda a: (lambda t: t.to(torch.bfloat16) if t.is_floating_point() else t)(torch.as_tensor(a)))
    def _A_setup():
        B, H, Sq, Sk, D, M = 2, 32, 1, 8192, 128, 512
        Dc = 4 * D
        return {
            "x": _w((lambda *s: torch.randn(*s, dtype=torch.bfloat16) * 0.05)(B, Sq, M)),
            "c_kv": _w((lambda *s: torch.randn(*s, dtype=torch.bfloat16) * 1.6)(B, Sk, Dc)),
            "w_q": _w((lambda *s: torch.randn(*s, dtype=torch.bfloat16) * 6.4)(M, H, D) * (M ** -0.5)),
            "w_uk": _w((lambda *s: torch.randn(*s, dtype=torch.bfloat16) * 6.4)(Dc, H, D) * (Dc ** -0.5)),
            "w_uv": _w((lambda *s: torch.randn(*s, dtype=torch.bfloat16) * 1.6)(Dc, H, D) * (Dc ** -0.5)),
            "w_o": _w((lambda *s: torch.randn(*s, dtype=torch.bfloat16) * 1.6)(H, D, M) * ((H * D) ** -0.5)),
        }
    _A_in = _A_setup()

    def _B_setup():
        B, S, D, F = 2, 1, 512, 1792
        return {
            "x": _w((lambda *s: torch.randn(*s, dtype=torch.bfloat16) * 0.05)(B, S, D)),
            "w_gate": _w((lambda *s: torch.randn(*s, dtype=torch.bfloat16) * 0.4)(D, F)),
            "w_up": _w((lambda *s: torch.randn(*s, dtype=torch.bfloat16) * 0.4)(D, F)),
            "w_down": _w((lambda *s: torch.randn(*s, dtype=torch.bfloat16) * 0.4)(F, D)),
        }
    _B_in = _B_setup()

    return {
        "A_x": _A_in["x"],
        "A_c_kv": _A_in["c_kv"],
        "A_w_q": _A_in["w_q"],
        "A_w_uk": _A_in["w_uk"],
        "A_w_uv": _A_in["w_uv"],
        "A_w_o": _A_in["w_o"],
        "B_x": _B_in["x"],
        "B_w_gate": _B_in["w_gate"],
        "B_w_up": _B_in["w_up"],
        "B_w_down": _B_in["w_down"],
        "gate_w": _w((lambda *s: torch.randn(*s, dtype=torch.bfloat16) * 0.1)(512) * 16.0),
    }

def reference(A_x, A_c_kv, A_w_q, A_w_uk, A_w_uv, A_w_o, B_x, B_w_gate, B_w_up, B_w_down, gate_w):
    def _A_ref(x, c_kv, w_q, w_uk, w_uv, w_o):
        B, Sq, M = x.shape[0], x.shape[1], x.shape[2]
        Sk = c_kv.shape[1]
        H, D = w_q.shape[1], w_q.shape[2]
        q = torch.einsum("bqm,mhd->bhqd", x, w_q)
        k = torch.einsum("bkc,chd->bhkd", c_kv, w_uk)
        v = torch.einsum("bkc,chd->bhkd", c_kv, w_uv)
        scores = torch.einsum("bhqd,bhkd->bhqk", q, k) * (D ** -0.5)
        off = Sk - Sq
        qi = torch.arange(Sq)[:, None]
        kj = torch.arange(Sk)[None, :]
        cmask = kj <= (qi + off)
        scores = torch.where(cmask[None, None], scores, -1e9)
        p = _softmax(scores, axis=-1)
        ctx = torch.einsum("bhqk,bhkd->bhqd", p, v)
        return torch.einsum("bhqd,hdm->bqm", ctx, w_o)

    def _B_ref(x, w_gate, w_up, w_down):
        return (_gelu(x @ w_gate) * (x @ w_up)) @ w_down

    x = A_x
    g = _sigmoid((x * gate_w).sum(-1, keepdims=True))
    a = _A_ref(x, A_c_kv, A_w_q, A_w_uk, A_w_uv, A_w_o)
    b = _B_ref(x, B_w_gate, B_w_up, B_w_down)
    return g * a + (1 - g) * b
```

```asm
; @launch grid=(256,1,1) block=(256,1,1) lds=163840
.amdgcn_target "amdgcn-amd-amdhsa--gfx950"
.text
.globl gated_mix__compressed_kv_cla__geglu_ffn__decode_kernel
.p2align 8
.type gated_mix__compressed_kv_cla__geglu_ffn__decode_kernel,@function
gated_mix__compressed_kv_cla__geglu_ffn__decode_kernel:
  s_cmp_ge_u32 s2, 256
  s_cbranch_scc1 k_end
  s_load_dwordx16 s[4:19], s[0:1], 0
  s_load_dwordx8 s[20:27], s[0:1], 64
  s_load_dwordx4 s[28:31], s[0:1], 96
  v_and_b32 v1, 63, v0
  v_lshrrev_b32 v2, 6, v0
  s_nop 0
  v_readfirstlane_b32 s33, v2
  s_mov_b32 s36, 0x05040100
  s_mov_b32 s37, 0x07060302
  s_waitcnt lgkmcnt(0)
  s_cmp_ge_u32 s2, 128
  s_cbranch_scc1 role_a
  s_mov_b32 s52, s2
  s_cmp_ge_u32 s2, 112
  s_cbranch_scc1 role_b2
  s_and_b32 s34, s52, 31
  s_lshr_b32 s35, s52, 5
  v_lshrrev_b32 v2, 4, v1
  v_and_b32 v3, 15, v1
  s_add_u32 s56, s35, 0
  s_and_b32 s56, s56, 3
  s_add_u32 s57, s35, 1
  s_and_b32 s57, s57, 3
  s_add_u32 s58, s35, 2
  s_and_b32 s58, s58, 3
  s_add_u32 s59, s35, 3
  s_and_b32 s59, s59, 3
  s_lshl_b32 s40, s33, 6
  v_lshlrev_b32 v12, 4, v2
  v_add_u32 v12, s40, v12
  s_lshl_b32 s40, s33, 18
  s_lshl_b32 s41, s34, 8
  s_add_u32 s40, s40, s41
  v_lshlrev_b32 v13, 16, v2
  v_lshlrev_b32 v11, 4, v3
  v_add_u32 v13, v13, v11
  v_add_u32 v13, s40, v13
  s_lshl_b32 s42, s56, 8
  v_add_u32 v10, s42, v12
  global_load_dwordx4 v[32:35], v10, s[4:5] offset:0
  global_load_dwordx4 v[36:39], v10, s[4:5] offset:1024
  s_lshl_b32 s42, s57, 8
  v_add_u32 v10, s42, v12
  global_load_dwordx4 v[40:43], v10, s[4:5] offset:0
  global_load_dwordx4 v[44:47], v10, s[4:5] offset:1024
  s_lshl_b32 s42, s58, 8
  v_add_u32 v10, s42, v12
  global_load_dwordx4 v[48:51], v10, s[4:5] offset:0
  global_load_dwordx4 v[52:55], v10, s[4:5] offset:1024
  s_lshl_b32 s42, s59, 8
  v_add_u32 v10, s42, v12
  global_load_dwordx4 v[56:59], v10, s[4:5] offset:0
  global_load_dwordx4 v[60:63], v10, s[4:5] offset:1024
  s_lshl_b32 s42, s56, 20
  v_add_u32 v10, s42, v13
  global_load_dwordx4 v[64:67], v10, s[8:9]
  v_add_u32 v10, 0x2000, v10
  global_load_dwordx4 v[68:71], v10, s[8:9]
  v_add_u32 v10, 0x2000, v10
  global_load_dwordx4 v[72:75], v10, s[8:9]
  v_add_u32 v10, 0x2000, v10
  global_load_dwordx4 v[76:79], v10, s[8:9]
  v_add_u32 v10, 0x2000, v10
  global_load_dwordx4 v[80:83], v10, s[8:9]
  v_add_u32 v10, 0x2000, v10
  global_load_dwordx4 v[84:87], v10, s[8:9]
  v_add_u32 v10, 0x2000, v10
  global_load_dwordx4 v[88:91], v10, s[8:9]
  v_add_u32 v10, 0x2000, v10
  global_load_dwordx4 v[92:95], v10, s[8:9]
  s_lshl_b32 s40, s35, 20
  s_lshl_b32 s42, s33, 18
  s_add_u32 s40, s40, s42
  s_add_u32 s40, s40, s41
  v_lshlrev_b32 v10, 13, v3
  v_lshlrev_b32 v11, 4, v2
  v_add_u32 v10, v10, v11
  v_add_u32 v10, s40, v10
  global_load_dwordx4 v[192:195], v10, s[10:11] offset:0
  global_load_dwordx4 v[196:199], v10, s[10:11] offset:64
  global_load_dwordx4 v[200:203], v10, s[10:11] offset:128
  global_load_dwordx4 v[204:207], v10, s[10:11] offset:192
  v_add_u32 v10, 0x20000, v10
  global_load_dwordx4 v[208:211], v10, s[10:11] offset:0
  global_load_dwordx4 v[212:215], v10, s[10:11] offset:64
  global_load_dwordx4 v[216:219], v10, s[10:11] offset:128
  global_load_dwordx4 v[220:223], v10, s[10:11] offset:192
  s_waitcnt vmcnt(8)
  s_lshl_b32 s42, s57, 20
  v_add_u32 v10, s42, v13
  global_load_dwordx4 v[96:99], v10, s[8:9]
  v_add_u32 v10, 0x2000, v10
  global_load_dwordx4 v[100:103], v10, s[8:9]
  v_add_u32 v10, 0x2000, v10
  global_load_dwordx4 v[104:107], v10, s[8:9]
  v_add_u32 v10, 0x2000, v10
  global_load_dwordx4 v[108:111], v10, s[8:9]
  v_add_u32 v10, 0x2000, v10
  global_load_dwordx4 v[112:115], v10, s[8:9]
  v_add_u32 v10, 0x2000, v10
  global_load_dwordx4 v[116:119], v10, s[8:9]
  v_add_u32 v10, 0x2000, v10
  global_load_dwordx4 v[120:123], v10, s[8:9]
  v_add_u32 v10, 0x2000, v10
  global_load_dwordx4 v[124:127], v10, s[8:9]
  s_lshl_b32 s42, s58, 20
  v_add_u32 v10, s42, v13
  global_load_dwordx4 v[128:131], v10, s[8:9]
  v_add_u32 v10, 0x2000, v10
  global_load_dwordx4 v[132:135], v10, s[8:9]
  v_add_u32 v10, 0x2000, v10
  global_load_dwordx4 v[136:139], v10, s[8:9]
  v_add_u32 v10, 0x2000, v10
  global_load_dwordx4 v[140:143], v10, s[8:9]
  v_add_u32 v10, 0x2000, v10
  global_load_dwordx4 v[144:147], v10, s[8:9]
  v_add_u32 v10, 0x2000, v10
  global_load_dwordx4 v[148:151], v10, s[8:9]
  v_add_u32 v10, 0x2000, v10
  global_load_dwordx4 v[152:155], v10, s[8:9]
  v_add_u32 v10, 0x2000, v10
  global_load_dwordx4 v[156:159], v10, s[8:9]
  s_lshl_b32 s42, s59, 20
  v_add_u32 v10, s42, v13
  global_load_dwordx4 v[160:163], v10, s[8:9]
  v_add_u32 v10, 0x2000, v10
  global_load_dwordx4 v[164:167], v10, s[8:9]
  v_add_u32 v10, 0x2000, v10
  global_load_dwordx4 v[168:171], v10, s[8:9]
  v_add_u32 v10, 0x2000, v10
  global_load_dwordx4 v[172:175], v10, s[8:9]
  v_add_u32 v10, 0x2000, v10
  global_load_dwordx4 v[176:179], v10, s[8:9]
  v_add_u32 v10, 0x2000, v10
  global_load_dwordx4 v[180:183], v10, s[8:9]
  v_add_u32 v10, 0x2000, v10
  global_load_dwordx4 v[184:187], v10, s[8:9]
  v_add_u32 v10, 0x2000, v10
  global_load_dwordx4 v[188:191], v10, s[8:9]
  v_mov_b32 v16, 0
  v_mov_b32 v17, 0
  v_mov_b32 v18, 0
  v_mov_b32 v19, 0
  v_mov_b32 v20, 0
  v_mov_b32 v21, 0
  v_mov_b32 v22, 0
  v_mov_b32 v23, 0
  v_mov_b32 v24, 0
  v_mov_b32 v25, 0
  v_mov_b32 v26, 0
  v_mov_b32 v27, 0
  v_mov_b32 v28, 0
  v_mov_b32 v29, 0
  v_mov_b32 v30, 0
  v_mov_b32 v31, 0
  v_perm_b32 v4, v68, v64, s36
  v_perm_b32 v5, v68, v64, s37
  v_dot2c_f32_bf16 v16, v4, v32
  v_dot2c_f32_bf16 v17, v5, v32
  v_dot2c_f32_bf16 v24, v4, v36
  v_dot2c_f32_bf16 v25, v5, v36
  v_perm_b32 v4, v69, v65, s36
  v_perm_b32 v5, v69, v65, s37
  v_dot2c_f32_bf16 v18, v4, v32
  v_dot2c_f32_bf16 v19, v5, v32
  v_dot2c_f32_bf16 v26, v4, v36
  v_dot2c_f32_bf16 v27, v5, v36
  v_perm_b32 v4, v70, v66, s36
  v_perm_b32 v5, v70, v66, s37
  v_dot2c_f32_bf16 v20, v4, v32
  v_dot2c_f32_bf16 v21, v5, v32
  v_dot2c_f32_bf16 v28, v4, v36
  v_dot2c_f32_bf16 v29, v5, v36
  v_perm_b32 v4, v71, v67, s36
  v_perm_b32 v5, v71, v67, s37
  v_dot2c_f32_bf16 v22, v4, v32
  v_dot2c_f32_bf16 v23, v5, v32
  v_dot2c_f32_bf16 v30, v4, v36
  v_dot2c_f32_bf16 v31, v5, v36
  v_perm_b32 v4, v76, v72, s36
  v_perm_b32 v5, v76, v72, s37
  v_dot2c_f32_bf16 v16, v4, v33
  v_dot2c_f32_bf16 v17, v5, v33
  v_dot2c_f32_bf16 v24, v4, v37
  v_dot2c_f32_bf16 v25, v5, v37
  v_perm_b32 v4, v77, v73, s36
  v_perm_b32 v5, v77, v73, s37
  v_dot2c_f32_bf16 v18, v4, v33
  v_dot2c_f32_bf16 v19, v5, v33
  v_dot2c_f32_bf16 v26, v4, v37
  v_dot2c_f32_bf16 v27, v5, v37
  v_perm_b32 v4, v78, v74, s36
  v_perm_b32 v5, v78, v74, s37
  v_dot2c_f32_bf16 v20, v4, v33
  v_dot2c_f32_bf16 v21, v5, v33
  v_dot2c_f32_bf16 v28, v4, v37
  v_dot2c_f32_bf16 v29, v5, v37
  v_perm_b32 v4, v79, v75, s36
  v_perm_b32 v5, v79, v75, s37
  v_dot2c_f32_bf16 v22, v4, v33
  v_dot2c_f32_bf16 v23, v5, v33
  v_dot2c_f32_bf16 v30, v4, v37
  v_dot2c_f32_bf16 v31, v5, v37
  v_perm_b32 v4, v84, v80, s36
  v_perm_b32 v5, v84, v80, s37
  v_dot2c_f32_bf16 v16, v4, v34
  v_dot2c_f32_bf16 v17, v5, v34
  v_dot2c_f32_bf16 v24, v4, v38
  v_dot2c_f32_bf16 v25, v5, v38
  v_perm_b32 v4, v85, v81, s36
  v_perm_b32 v5, v85, v81, s37
  v_dot2c_f32_bf16 v18, v4, v34
  v_dot2c_f32_bf16 v19, v5, v34
  v_dot2c_f32_bf16 v26, v4, v38
  v_dot2c_f32_bf16 v27, v5, v38
  v_perm_b32 v4, v86, v82, s36
  v_perm_b32 v5, v86, v82, s37
  v_dot2c_f32_bf16 v20, v4, v34
  v_dot2c_f32_bf16 v21, v5, v34
  v_dot2c_f32_bf16 v28, v4, v38
  v_dot2c_f32_bf16 v29, v5, v38
  v_perm_b32 v4, v87, v83, s36
  v_perm_b32 v5, v87, v83, s37
  v_dot2c_f32_bf16 v22, v4, v34
  v_dot2c_f32_bf16 v23, v5, v34
  v_dot2c_f32_bf16 v30, v4, v38
  v_dot2c_f32_bf16 v31, v5, v38
  v_perm_b32 v4, v92, v88, s36
  v_perm_b32 v5, v92, v88, s37
  v_dot2c_f32_bf16 v16, v4, v35
  v_dot2c_f32_bf16 v17, v5, v35
  v_dot2c_f32_bf16 v24, v4, v39
  v_dot2c_f32_bf16 v25, v5, v39
  v_perm_b32 v4, v93, v89, s36
  v_perm_b32 v5, v93, v89, s37
  v_dot2c_f32_bf16 v18, v4, v35
  v_dot2c_f32_bf16 v19, v5, v35
  v_dot2c_f32_bf16 v26, v4, v39
  v_dot2c_f32_bf16 v27, v5, v39
  v_perm_b32 v4, v94, v90, s36
  v_perm_b32 v5, v94, v90, s37
  v_dot2c_f32_bf16 v20, v4, v35
  v_dot2c_f32_bf16 v21, v5, v35
  v_dot2c_f32_bf16 v28, v4, v39
  v_dot2c_f32_bf16 v29, v5, v39
  v_perm_b32 v4, v95, v91, s36
  v_perm_b32 v5, v95, v91, s37
  v_dot2c_f32_bf16 v22, v4, v35
  v_dot2c_f32_bf16 v23, v5, v35
  v_dot2c_f32_bf16 v30, v4, v39
  v_dot2c_f32_bf16 v31, v5, v39
  s_waitcnt vmcnt(16)
  v_perm_b32 v4, v100, v96, s36
  v_perm_b32 v5, v100, v96, s37
  v_dot2c_f32_bf16 v16, v4, v40
  v_dot2c_f32_bf16 v17, v5, v40
  v_dot2c_f32_bf16 v24, v4, v44
  v_dot2c_f32_bf16 v25, v5, v44
  v_perm_b32 v4, v101, v97, s36
  v_perm_b32 v5, v101, v97, s37
  v_dot2c_f32_bf16 v18, v4, v40
  v_dot2c_f32_bf16 v19, v5, v40
  v_dot2c_f32_bf16 v26, v4, v44
  v_dot2c_f32_bf16 v27, v5, v44
  v_perm_b32 v4, v102, v98, s36
  v_perm_b32 v5, v102, v98, s37
  v_dot2c_f32_bf16 v20, v4, v40
  v_dot2c_f32_bf16 v21, v5, v40
  v_dot2c_f32_bf16 v28, v4, v44
  v_dot2c_f32_bf16 v29, v5, v44
  v_perm_b32 v4, v103, v99, s36
  v_perm_b32 v5, v103, v99, s37
  v_dot2c_f32_bf16 v22, v4, v40
  v_dot2c_f32_bf16 v23, v5, v40
  v_dot2c_f32_bf16 v30, v4, v44
  v_dot2c_f32_bf16 v31, v5, v44
  v_perm_b32 v4, v108, v104, s36
  v_perm_b32 v5, v108, v104, s37
  v_dot2c_f32_bf16 v16, v4, v41
  v_dot2c_f32_bf16 v17, v5, v41
  v_dot2c_f32_bf16 v24, v4, v45
  v_dot2c_f32_bf16 v25, v5, v45
  v_perm_b32 v4, v109, v105, s36
  v_perm_b32 v5, v109, v105, s37
  v_dot2c_f32_bf16 v18, v4, v41
  v_dot2c_f32_bf16 v19, v5, v41
  v_dot2c_f32_bf16 v26, v4, v45
  v_dot2c_f32_bf16 v27, v5, v45
  v_perm_b32 v4, v110, v106, s36
  v_perm_b32 v5, v110, v106, s37
  v_dot2c_f32_bf16 v20, v4, v41
  v_dot2c_f32_bf16 v21, v5, v41
  v_dot2c_f32_bf16 v28, v4, v45
  v_dot2c_f32_bf16 v29, v5, v45
  v_perm_b32 v4, v111, v107, s36
  v_perm_b32 v5, v111, v107, s37
  v_dot2c_f32_bf16 v22, v4, v41
  v_dot2c_f32_bf16 v23, v5, v41
  v_dot2c_f32_bf16 v30, v4, v45
  v_dot2c_f32_bf16 v31, v5, v45
  v_perm_b32 v4, v116, v112, s36
  v_perm_b32 v5, v116, v112, s37
  v_dot2c_f32_bf16 v16, v4, v42
  v_dot2c_f32_bf16 v17, v5, v42
  v_dot2c_f32_bf16 v24, v4, v46
  v_dot2c_f32_bf16 v25, v5, v46
  v_perm_b32 v4, v117, v113, s36
  v_perm_b32 v5, v117, v113, s37
  v_dot2c_f32_bf16 v18, v4, v42
  v_dot2c_f32_bf16 v19, v5, v42
  v_dot2c_f32_bf16 v26, v4, v46
  v_dot2c_f32_bf16 v27, v5, v46
  v_perm_b32 v4, v118, v114, s36
  v_perm_b32 v5, v118, v114, s37
  v_dot2c_f32_bf16 v20, v4, v42
  v_dot2c_f32_bf16 v21, v5, v42
  v_dot2c_f32_bf16 v28, v4, v46
  v_dot2c_f32_bf16 v29, v5, v46
  v_perm_b32 v4, v119, v115, s36
  v_perm_b32 v5, v119, v115, s37
  v_dot2c_f32_bf16 v22, v4, v42
  v_dot2c_f32_bf16 v23, v5, v42
  v_dot2c_f32_bf16 v30, v4, v46
  v_dot2c_f32_bf16 v31, v5, v46
  v_perm_b32 v4, v124, v120, s36
  v_perm_b32 v5, v124, v120, s37
  v_dot2c_f32_bf16 v16, v4, v43
  v_dot2c_f32_bf16 v17, v5, v43
  v_dot2c_f32_bf16 v24, v4, v47
  v_dot2c_f32_bf16 v25, v5, v47
  v_perm_b32 v4, v125, v121, s36
  v_perm_b32 v5, v125, v121, s37
  v_dot2c_f32_bf16 v18, v4, v43
  v_dot2c_f32_bf16 v19, v5, v43
  v_dot2c_f32_bf16 v26, v4, v47
  v_dot2c_f32_bf16 v27, v5, v47
  v_perm_b32 v4, v126, v122, s36
  v_perm_b32 v5, v126, v122, s37
  v_dot2c_f32_bf16 v20, v4, v43
  v_dot2c_f32_bf16 v21, v5, v43
  v_dot2c_f32_bf16 v28, v4, v47
  v_dot2c_f32_bf16 v29, v5, v47
  v_perm_b32 v4, v127, v123, s36
  v_perm_b32 v5, v127, v123, s37
  v_dot2c_f32_bf16 v22, v4, v43
  v_dot2c_f32_bf16 v23, v5, v43
  v_dot2c_f32_bf16 v30, v4, v47
  v_dot2c_f32_bf16 v31, v5, v47
  s_waitcnt vmcnt(8)
  v_perm_b32 v4, v132, v128, s36
  v_perm_b32 v5, v132, v128, s37
  v_dot2c_f32_bf16 v16, v4, v48
  v_dot2c_f32_bf16 v17, v5, v48
  v_dot2c_f32_bf16 v24, v4, v52
  v_dot2c_f32_bf16 v25, v5, v52
  v_perm_b32 v4, v133, v129, s36
  v_perm_b32 v5, v133, v129, s37
  v_dot2c_f32_bf16 v18, v4, v48
  v_dot2c_f32_bf16 v19, v5, v48
  v_dot2c_f32_bf16 v26, v4, v52
  v_dot2c_f32_bf16 v27, v5, v52
  v_perm_b32 v4, v134, v130, s36
  v_perm_b32 v5, v134, v130, s37
  v_dot2c_f32_bf16 v20, v4, v48
  v_dot2c_f32_bf16 v21, v5, v48
  v_dot2c_f32_bf16 v28, v4, v52
  v_dot2c_f32_bf16 v29, v5, v52
  v_perm_b32 v4, v135, v131, s36
  v_perm_b32 v5, v135, v131, s37
  v_dot2c_f32_bf16 v22, v4, v48
  v_dot2c_f32_bf16 v23, v5, v48
  v_dot2c_f32_bf16 v30, v4, v52
  v_dot2c_f32_bf16 v31, v5, v52
  v_perm_b32 v4, v140, v136, s36
  v_perm_b32 v5, v140, v136, s37
  v_dot2c_f32_bf16 v16, v4, v49
  v_dot2c_f32_bf16 v17, v5, v49
  v_dot2c_f32_bf16 v24, v4, v53
  v_dot2c_f32_bf16 v25, v5, v53
  v_perm_b32 v4, v141, v137, s36
  v_perm_b32 v5, v141, v137, s37
  v_dot2c_f32_bf16 v18, v4, v49
  v_dot2c_f32_bf16 v19, v5, v49
  v_dot2c_f32_bf16 v26, v4, v53
  v_dot2c_f32_bf16 v27, v5, v53
  v_perm_b32 v4, v142, v138, s36
  v_perm_b32 v5, v142, v138, s37
  v_dot2c_f32_bf16 v20, v4, v49
  v_dot2c_f32_bf16 v21, v5, v49
  v_dot2c_f32_bf16 v28, v4, v53
  v_dot2c_f32_bf16 v29, v5, v53
  v_perm_b32 v4, v143, v139, s36
  v_perm_b32 v5, v143, v139, s37
  v_dot2c_f32_bf16 v22, v4, v49
  v_dot2c_f32_bf16 v23, v5, v49
  v_dot2c_f32_bf16 v30, v4, v53
  v_dot2c_f32_bf16 v31, v5, v53
  v_perm_b32 v4, v148, v144, s36
  v_perm_b32 v5, v148, v144, s37
  v_dot2c_f32_bf16 v16, v4, v50
  v_dot2c_f32_bf16 v17, v5, v50
  v_dot2c_f32_bf16 v24, v4, v54
  v_dot2c_f32_bf16 v25, v5, v54
  v_perm_b32 v4, v149, v145, s36
  v_perm_b32 v5, v149, v145, s37
  v_dot2c_f32_bf16 v18, v4, v50
  v_dot2c_f32_bf16 v19, v5, v50
  v_dot2c_f32_bf16 v26, v4, v54
  v_dot2c_f32_bf16 v27, v5, v54
  v_perm_b32 v4, v150, v146, s36
  v_perm_b32 v5, v150, v146, s37
  v_dot2c_f32_bf16 v20, v4, v50
  v_dot2c_f32_bf16 v21, v5, v50
  v_dot2c_f32_bf16 v28, v4, v54
  v_dot2c_f32_bf16 v29, v5, v54
  v_perm_b32 v4, v151, v147, s36
  v_perm_b32 v5, v151, v147, s37
  v_dot2c_f32_bf16 v22, v4, v50
  v_dot2c_f32_bf16 v23, v5, v50
  v_dot2c_f32_bf16 v30, v4, v54
  v_dot2c_f32_bf16 v31, v5, v54
  v_perm_b32 v4, v156, v152, s36
  v_perm_b32 v5, v156, v152, s37
  v_dot2c_f32_bf16 v16, v4, v51
  v_dot2c_f32_bf16 v17, v5, v51
  v_dot2c_f32_bf16 v24, v4, v55
  v_dot2c_f32_bf16 v25, v5, v55
  v_perm_b32 v4, v157, v153, s36
  v_perm_b32 v5, v157, v153, s37
  v_dot2c_f32_bf16 v18, v4, v51
  v_dot2c_f32_bf16 v19, v5, v51
  v_dot2c_f32_bf16 v26, v4, v55
  v_dot2c_f32_bf16 v27, v5, v55
  v_perm_b32 v4, v158, v154, s36
  v_perm_b32 v5, v158, v154, s37
  v_dot2c_f32_bf16 v20, v4, v51
  v_dot2c_f32_bf16 v21, v5, v51
  v_dot2c_f32_bf16 v28, v4, v55
  v_dot2c_f32_bf16 v29, v5, v55
  v_perm_b32 v4, v159, v155, s36
  v_perm_b32 v5, v159, v155, s37
  v_dot2c_f32_bf16 v22, v4, v51
  v_dot2c_f32_bf16 v23, v5, v51
  v_dot2c_f32_bf16 v30, v4, v55
  v_dot2c_f32_bf16 v31, v5, v55
  s_waitcnt vmcnt(0)
  v_perm_b32 v4, v164, v160, s36
  v_perm_b32 v5, v164, v160, s37
  v_dot2c_f32_bf16 v16, v4, v56
  v_dot2c_f32_bf16 v17, v5, v56
  v_dot2c_f32_bf16 v24, v4, v60
  v_dot2c_f32_bf16 v25, v5, v60
  v_perm_b32 v4, v165, v161, s36
  v_perm_b32 v5, v165, v161, s37
  v_dot2c_f32_bf16 v18, v4, v56
  v_dot2c_f32_bf16 v19, v5, v56
  v_dot2c_f32_bf16 v26, v4, v60
  v_dot2c_f32_bf16 v27, v5, v60
  v_perm_b32 v4, v166, v162, s36
  v_perm_b32 v5, v166, v162, s37
  v_dot2c_f32_bf16 v20, v4, v56
  v_dot2c_f32_bf16 v21, v5, v56
  v_dot2c_f32_bf16 v28, v4, v60
  v_dot2c_f32_bf16 v29, v5, v60
  v_perm_b32 v4, v167, v163, s36
  v_perm_b32 v5, v167, v163, s37
  v_dot2c_f32_bf16 v22, v4, v56
  v_dot2c_f32_bf16 v23, v5, v56
  v_dot2c_f32_bf16 v30, v4, v60
  v_dot2c_f32_bf16 v31, v5, v60
  v_perm_b32 v4, v172, v168, s36
  v_perm_b32 v5, v172, v168, s37
  v_dot2c_f32_bf16 v16, v4, v57
  v_dot2c_f32_bf16 v17, v5, v57
  v_dot2c_f32_bf16 v24, v4, v61
  v_dot2c_f32_bf16 v25, v5, v61
  v_perm_b32 v4, v173, v169, s36
  v_perm_b32 v5, v173, v169, s37
  v_dot2c_f32_bf16 v18, v4, v57
  v_dot2c_f32_bf16 v19, v5, v57
  v_dot2c_f32_bf16 v26, v4, v61
  v_dot2c_f32_bf16 v27, v5, v61
  v_perm_b32 v4, v174, v170, s36
  v_perm_b32 v5, v174, v170, s37
  v_dot2c_f32_bf16 v20, v4, v57
  v_dot2c_f32_bf16 v21, v5, v57
  v_dot2c_f32_bf16 v28, v4, v61
  v_dot2c_f32_bf16 v29, v5, v61
  v_perm_b32 v4, v175, v171, s36
  v_perm_b32 v5, v175, v171, s37
  v_dot2c_f32_bf16 v22, v4, v57
  v_dot2c_f32_bf16 v23, v5, v57
  v_dot2c_f32_bf16 v30, v4, v61
  v_dot2c_f32_bf16 v31, v5, v61
  v_perm_b32 v4, v180, v176, s36
  v_perm_b32 v5, v180, v176, s37
  v_dot2c_f32_bf16 v16, v4, v58
  v_dot2c_f32_bf16 v17, v5, v58
  v_dot2c_f32_bf16 v24, v4, v62
  v_dot2c_f32_bf16 v25, v5, v62
  v_perm_b32 v4, v181, v177, s36
  v_perm_b32 v5, v181, v177, s37
  v_dot2c_f32_bf16 v18, v4, v58
  v_dot2c_f32_bf16 v19, v5, v58
  v_dot2c_f32_bf16 v26, v4, v62
  v_dot2c_f32_bf16 v27, v5, v62
  v_perm_b32 v4, v182, v178, s36
  v_perm_b32 v5, v182, v178, s37
  v_dot2c_f32_bf16 v20, v4, v58
  v_dot2c_f32_bf16 v21, v5, v58
  v_dot2c_f32_bf16 v28, v4, v62
  v_dot2c_f32_bf16 v29, v5, v62
  v_perm_b32 v4, v183, v179, s36
  v_perm_b32 v5, v183, v179, s37
  v_dot2c_f32_bf16 v22, v4, v58
  v_dot2c_f32_bf16 v23, v5, v58
  v_dot2c_f32_bf16 v30, v4, v62
  v_dot2c_f32_bf16 v31, v5, v62
  v_perm_b32 v4, v188, v184, s36
  v_perm_b32 v5, v188, v184, s37
  v_dot2c_f32_bf16 v16, v4, v59
  v_dot2c_f32_bf16 v17, v5, v59
  v_dot2c_f32_bf16 v24, v4, v63
  v_dot2c_f32_bf16 v25, v5, v63
  v_perm_b32 v4, v189, v185, s36
  v_perm_b32 v5, v189, v185, s37
  v_dot2c_f32_bf16 v18, v4, v59
  v_dot2c_f32_bf16 v19, v5, v59
  v_dot2c_f32_bf16 v26, v4, v63
  v_dot2c_f32_bf16 v27, v5, v63
  v_perm_b32 v4, v190, v186, s36
  v_perm_b32 v5, v190, v186, s37
  v_dot2c_f32_bf16 v20, v4, v59
  v_dot2c_f32_bf16 v21, v5, v59
  v_dot2c_f32_bf16 v28, v4, v63
  v_dot2c_f32_bf16 v29, v5, v63
  v_perm_b32 v4, v191, v187, s36
  v_perm_b32 v5, v191, v187, s37
  v_dot2c_f32_bf16 v22, v4, v59
  v_dot2c_f32_bf16 v23, v5, v59
  v_dot2c_f32_bf16 v30, v4, v63
  v_dot2c_f32_bf16 v31, v5, v63
  s_nop 2
  s_lshl_b32 s40, s33, 12
  v_lshlrev_b32 v10, 10, v2
  v_lshlrev_b32 v11, 5, v3
  v_add_u32 v10, v10, v11
  v_add_u32 v10, s40, v10
  s_nop 0
  ds_write_b128 v10, v[16:19] offset:0
  ds_write_b128 v10, v[20:23] offset:16
  ds_write_b128 v10, v[24:27] offset:512
  ds_write_b128 v10, v[28:31] offset:528
  s_waitcnt lgkmcnt(0)
  s_barrier
  v_lshlrev_b32 v10, 2, v0
  ds_read_b32 v32, v10 offset:0
  ds_read_b32 v33, v10 offset:1024
  ds_read_b32 v34, v10 offset:2048
  ds_read_b32 v35, v10 offset:3072
  ds_read_b32 v36, v10 offset:4096
  ds_read_b32 v37, v10 offset:5120
  ds_read_b32 v38, v10 offset:6144
  ds_read_b32 v39, v10 offset:7168
  ds_read_b32 v40, v10 offset:8192
  ds_read_b32 v41, v10 offset:9216
  ds_read_b32 v42, v10 offset:10240
  ds_read_b32 v43, v10 offset:11264
  ds_read_b32 v44, v10 offset:12288
  ds_read_b32 v45, v10 offset:13312
  ds_read_b32 v46, v10 offset:14336
  ds_read_b32 v47, v10 offset:15360
  s_waitcnt lgkmcnt(0)
  v_add_f32 v32, v32, v40
  v_add_f32 v33, v33, v41
  v_add_f32 v34, v34, v42
  v_add_f32 v35, v35, v43
  v_add_f32 v36, v36, v44
  v_add_f32 v37, v37, v45
  v_add_f32 v38, v38, v46
  v_add_f32 v39, v39, v47
  v_add_f32 v32, v32, v36
  v_add_f32 v33, v33, v37
  v_add_f32 v34, v34, v38
  v_add_f32 v35, v35, v39
  v_add_f32 v32, v32, v34
  v_add_f32 v33, v33, v35
  v_add_f32 v32, v32, v33
  v_cvt_pk_bf16_f32 v32, v32, v32
  v_lshlrev_b32 v10, 1, v0
  ds_write_b16 v10, v32 offset:32768
  s_waitcnt lgkmcnt(0)
  s_barrier
  v_and_b32 v10, 1, v1
  v_lshlrev_b32 v10, 8, v10
  v_lshlrev_b32 v11, 4, v2
  v_add_u32 v10, v10, v11
  ds_read_b128 v[32:35], v10 offset:32768
  ds_read_b128 v[36:39], v10 offset:32832
  ds_read_b128 v[40:43], v10 offset:32896
  ds_read_b128 v[44:47], v10 offset:32960
  v_mov_b32 v16, 0
  v_mov_b32 v17, 0
  v_mov_b32 v18, 0
  v_mov_b32 v19, 0
  v_mov_b32 v20, 0
  v_mov_b32 v21, 0
  v_mov_b32 v22, 0
  v_mov_b32 v23, 0
  s_waitcnt lgkmcnt(0)
  v_mfma_f32_16x16x32_bf16 v[16:19], v[192:195], v[32:35], v[16:19]
  v_mfma_f32_16x16x32_bf16 v[20:23], v[208:211], v[32:35], v[20:23]
  v_mfma_f32_16x16x32_bf16 v[16:19], v[196:199], v[36:39], v[16:19]
  v_mfma_f32_16x16x32_bf16 v[20:23], v[212:215], v[36:39], v[20:23]
  v_mfma_f32_16x16x32_bf16 v[16:19], v[200:203], v[40:43], v[16:19]
  v_mfma_f32_16x16x32_bf16 v[20:23], v[216:219], v[40:43], v[20:23]
  v_mfma_f32_16x16x32_bf16 v[16:19], v[204:207], v[44:47], v[16:19]
  v_mfma_f32_16x16x32_bf16 v[20:23], v[220:223], v[44:47], v[20:23]
  s_cmp_lg_u32 s33, 0
  s_cbranch_scc1 Lfwd_2
  s_mov_b32 s38, 200000
  v_and_b32 v4, 7, v1
  v_lshlrev_b32 v4, 2, v4
Lfw_1:
  global_load_dword v5, v4, s[28:29] sc1
  s_waitcnt vmcnt(0)
  v_cmp_ne_u32 vcc, 16, v5
  s_cbranch_vccz Lfwd_2
  s_sub_u32 s38, s38, 1
  s_cmp_eq_u32 s38, 0
  s_cbranch_scc1 Lfwd_2
  s_sleep 8
  s_branch Lfw_1
Lfwd_2:
  s_barrier
  s_lshl_b32 s40, s34, 10
  s_lshl_b32 s41, s35, 8
  s_add_u32 s40, s40, s41
  s_lshl_b32 s41, s33, 6
  s_add_u32 s40, s40, s41
  v_lshlrev_b32 v10, 15, v3
  v_lshlrev_b32 v11, 3, v2
  v_add_u32 v10, v10, v11
  v_add_u32 v10, s40, v10
  s_nop 7
  v_cvt_pk_bf16_f32 v4, v16, v17
  v_cvt_pk_bf16_f32 v5, v18, v19
  v_cvt_pk_bf16_f32 v6, v20, v21
  v_cvt_pk_bf16_f32 v7, v22, v23
  v_min_u32 v4, -2, v4
  v_min_u32 v5, -2, v5
  v_min_u32 v6, -2, v6
  v_min_u32 v7, -2, v7
  v_cmp_gt_u32 vcc, 2, v3
  s_and_saveexec_b64 s[48:49], vcc
  global_store_dwordx2 v10, v[4:5], s[30:31] offset:0 sc1
  global_store_dwordx2 v10, v[6:7], s[30:31] offset:32 sc1
  s_mov_b64 exec, s[48:49]
  v_lshrrev_b32 v12, 1, v1
  v_and_b32 v13, 1, v1
  s_lshl_b32 s40, s33, 8
  v_lshlrev_b32 v10, 3, v12
  v_add_u32 v10, s40, v10
  global_load_dwordx2 v[48:49], v10, s[4:5] offset:0
  global_load_dwordx2 v[50:51], v10, s[4:5] offset:1024
  s_mul_i32 s40, s33, 458752
  s_lshl_b32 s41, s52, 5
  s_add_u32 s40, s40, s41
  s_mov_b32 s41, 14336
  v_mul_lo_u32 v10, v12, s41
  v_lshlrev_b32 v11, 4, v13
  v_add_u32 v10, v10, v11
  v_add_u32 v10, s40, v10
  global_load_dwordx4 v[192:195], v10, s[18:19]
  global_load_dwordx4 v[208:211], v10, s[20:21]
  v_add_u32 v10, 3584, v10
  global_load_dwordx4 v[196:199], v10, s[18:19]
  global_load_dwordx4 v[212:215], v10, s[20:21]
  v_add_u32 v10, 3584, v10
  global_load_dwordx4 v[200:203], v10, s[18:19]
  global_load_dwordx4 v[216:219], v10, s[20:21]
  v_add_u32 v10, 3584, v10
  global_load_dwordx4 v[204:207], v10, s[18:19]
  global_load_dwordx4 v[220:223], v10, s[20:21]
  s_lshl_b32 s40, s52, 14
  s_lshl_b32 s41, s33, 12
  s_add_u32 s40, s40, s41
  v_lshlrev_b32 v10, 4, v1
  v_add_u32 v10, s40, v10
  global_load_dwordx4 v[32:35], v10, s[22:23] offset:0
  global_load_dwordx4 v[36:39], v10, s[22:23] offset:1024
  global_load_dwordx4 v[40:43], v10, s[22:23] offset:2048
  global_load_dwordx4 v[44:47], v10, s[22:23] offset:3072
  s_lshl_b32 s40, s35, 20
  s_lshl_b32 s42, s33, 18
  s_add_u32 s40, s40, s42
  s_lshl_b32 s41, s34, 8
  s_add_u32 s40, s40, s41
  v_lshlrev_b32 v10, 16, v2
  v_lshlrev_b32 v11, 4, v3
  v_add_u32 v10, v10, v11
  v_add_u32 v10, s40, v10
  global_load_dwordx4 v[224:227], v10, s[12:13]
  v_add_u32 v10, 0x2000, v10
  global_load_dwordx4 v[228:231], v10, s[12:13]
  v_add_u32 v10, 0x2000, v10
  global_load_dwordx4 v[232:235], v10, s[12:13]
  v_add_u32 v10, 0x2000, v10
  global_load_dwordx4 v[236:239], v10, s[12:13]
  v_add_u32 v10, 0x2000, v10
  global_load_dwordx4 v[240:243], v10, s[12:13]
  v_add_u32 v10, 0x2000, v10
  global_load_dwordx4 v[244:247], v10, s[12:13]
  v_add_u32 v10, 0x2000, v10
  global_load_dwordx4 v[248:251], v10, s[12:13]
  v_add_u32 v10, 0x2000, v10
  global_load_dwordx4 v[252:255], v10, s[12:13]
  s_lshl_b32 s40, s34, 17
  s_lshl_b32 s41, s33, 13
  s_add_u32 s40, s40, s41
  v_lshlrev_b32 v13, 4, v1
  v_add_u32 v13, s40, v13
  s_lshl_b32 s42, s56, 15
  v_add_u32 v10, s42, v13
  global_load_dwordx4 v[64:67], v10, s[14:15] offset:0
  global_load_dwordx4 v[68:71], v10, s[14:15] offset:1024
  global_load_dwordx4 v[72:75], v10, s[14:15] offset:2048
  global_load_dwordx4 v[76:79], v10, s[14:15] offset:3072
  v_add_u32 v10, 0x1000, v10
  global_load_dwordx4 v[80:83], v10, s[14:15] offset:0
  global_load_dwordx4 v[84:87], v10, s[14:15] offset:1024
  global_load_dwordx4 v[88:91], v10, s[14:15] offset:2048
  global_load_dwordx4 v[92:95], v10, s[14:15] offset:3072
  s_waitcnt vmcnt(0)
  s_lshl_b32 s42, s57, 15
  v_add_u32 v10, s42, v13
  global_load_dwordx4 v[96:99], v10, s[14:15] offset:0
  global_load_dwordx4 v[100:103], v10, s[14:15] offset:1024
  global_load_dwordx4 v[104:107], v10, s[14:15] offset:2048
  global_load_dwordx4 v[108:111], v10, s[14:15] offset:3072
  v_add_u32 v10, 0x1000, v10
  global_load_dwordx4 v[112:115], v10, s[14:15] offset:0
  global_load_dwordx4 v[116:119], v10, s[14:15] offset:1024
  global_load_dwordx4 v[120:123], v10, s[14:15] offset:2048
  global_load_dwordx4 v[124:127], v10, s[14:15] offset:3072
  s_lshl_b32 s42, s58, 15
  v_add_u32 v10, s42, v13
  global_load_dwordx4 v[128:131], v10, s[14:15] offset:0
  global_load_dwordx4 v[132:135], v10, s[14:15] offset:1024
  global_load_dwordx4 v[136:139], v10, s[14:15] offset:2048
  global_load_dwordx4 v[140:143], v10, s[14:15] offset:3072
  v_add_u32 v10, 0x1000, v10
  global_load_dwordx4 v[144:147], v10, s[14:15] offset:0
  global_load_dwordx4 v[148:151], v10, s[14:15] offset:1024
  global_load_dwordx4 v[152:155], v10, s[14:15] offset:2048
  global_load_dwordx4 v[156:159], v10, s[14:15] offset:3072
  s_lshl_b32 s42, s59, 15
  v_add_u32 v10, s42, v13
  global_load_dwordx4 v[160:163], v10, s[14:15] offset:0
  global_load_dwordx4 v[164:167], v10, s[14:15] offset:1024
  global_load_dwordx4 v[168:171], v10, s[14:15] offset:2048
  global_load_dwordx4 v[172:175], v10, s[14:15] offset:3072
  v_add_u32 v10, 0x1000, v10
  global_load_dwordx4 v[176:179], v10, s[14:15] offset:0
  global_load_dwordx4 v[180:183], v10, s[14:15] offset:1024
  global_load_dwordx4 v[184:187], v10, s[14:15] offset:2048
  global_load_dwordx4 v[188:191], v10, s[14:15] offset:3072
  v_lshrrev_b32 v12, 1, v1
  v_and_b32 v13, 1, v1
  v_mov_b32 v16, 0
  v_mov_b32 v17, 0
  v_mov_b32 v18, 0
  v_mov_b32 v19, 0
  v_mov_b32 v20, 0
  v_mov_b32 v21, 0
  v_mov_b32 v22, 0
  v_mov_b32 v23, 0
  v_mov_b32 v24, 0
  v_mov_b32 v25, 0
  v_mov_b32 v26, 0
  v_mov_b32 v27, 0
  v_mov_b32 v28, 0
  v_mov_b32 v29, 0
  v_mov_b32 v30, 0
  v_mov_b32 v31, 0
  v_perm_b32 v4, v196, v192, s36
  v_perm_b32 v5, v196, v192, s37
  v_dot2c_f32_bf16 v16, v4, v48
  v_dot2c_f32_bf16 v17, v5, v48
  v_dot2c_f32_bf16 v24, v4, v50
  v_dot2c_f32_bf16 v25, v5, v50
  v_perm_b32 v4, v197, v193, s36
  v_perm_b32 v5, v197, v193, s37
  v_dot2c_f32_bf16 v18, v4, v48
  v_dot2c_f32_bf16 v19, v5, v48
  v_dot2c_f32_bf16 v26, v4, v50
  v_dot2c_f32_bf16 v27, v5, v50
  v_perm_b32 v4, v198, v194, s36
  v_perm_b32 v5, v198, v194, s37
  v_dot2c_f32_bf16 v20, v4, v48
  v_dot2c_f32_bf16 v21, v5, v48
  v_dot2c_f32_bf16 v28, v4, v50
  v_dot2c_f32_bf16 v29, v5, v50
  v_perm_b32 v4, v199, v195, s36
  v_perm_b32 v5, v199, v195, s37
  v_dot2c_f32_bf16 v22, v4, v48
  v_dot2c_f32_bf16 v23, v5, v48
  v_dot2c_f32_bf16 v30, v4, v50
  v_dot2c_f32_bf16 v31, v5, v50
  v_perm_b32 v4, v204, v200, s36
  v_perm_b32 v5, v204, v200, s37
  v_dot2c_f32_bf16 v16, v4, v49
  v_dot2c_f32_bf16 v17, v5, v49
  v_dot2c_f32_bf16 v24, v4, v51
  v_dot2c_f32_bf16 v25, v5, v51
  v_perm_b32 v4, v205, v201, s36
  v_perm_b32 v5, v205, v201, s37
  v_dot2c_f32_bf16 v18, v4, v49
  v_dot2c_f32_bf16 v19, v5, v49
  v_dot2c_f32_bf16 v26, v4, v51
  v_dot2c_f32_bf16 v27, v5, v51
  v_perm_b32 v4, v206, v202, s36
  v_perm_b32 v5, v206, v202, s37
  v_dot2c_f32_bf16 v20, v4, v49
  v_dot2c_f32_bf16 v21, v5, v49
  v_dot2c_f32_bf16 v28, v4, v51
  v_dot2c_f32_bf16 v29, v5, v51
  v_perm_b32 v4, v207, v203, s36
  v_perm_b32 v5, v207, v203, s37
  v_dot2c_f32_bf16 v22, v4, v49
  v_dot2c_f32_bf16 v23, v5, v49
  v_dot2c_f32_bf16 v30, v4, v51
  v_dot2c_f32_bf16 v31, v5, v51
  v_mov_b32 v192, 0
  v_mov_b32 v193, 0
  v_mov_b32 v194, 0
  v_mov_b32 v195, 0
  v_mov_b32 v196, 0
  v_mov_b32 v197, 0
  v_mov_b32 v198, 0
  v_mov_b32 v199, 0
  v_mov_b32 v200, 0
  v_mov_b32 v201, 0
  v_mov_b32 v202, 0
  v_mov_b32 v203, 0
  v_mov_b32 v204, 0
  v_mov_b32 v205, 0
  v_mov_b32 v206, 0
  v_mov_b32 v207, 0
  v_perm_b32 v4, v212, v208, s36
  v_perm_b32 v5, v212, v208, s37
  v_dot2c_f32_bf16 v192, v4, v48
  v_dot2c_f32_bf16 v193, v5, v48
  v_dot2c_f32_bf16 v200, v4, v50
  v_dot2c_f32_bf16 v201, v5, v50
  v_perm_b32 v4, v213, v209, s36
  v_perm_b32 v5, v213, v209, s37
  v_dot2c_f32_bf16 v194, v4, v48
  v_dot2c_f32_bf16 v195, v5, v48
  v_dot2c_f32_bf16 v202, v4, v50
  v_dot2c_f32_bf16 v203, v5, v50
  v_perm_b32 v4, v214, v210, s36
  v_perm_b32 v5, v214, v210, s37
  v_dot2c_f32_bf16 v196, v4, v48
  v_dot2c_f32_bf16 v197, v5, v48
  v_dot2c_f32_bf16 v204, v4, v50
  v_dot2c_f32_bf16 v205, v5, v50
  v_perm_b32 v4, v215, v211, s36
  v_perm_b32 v5, v215, v211, s37
  v_dot2c_f32_bf16 v198, v4, v48
  v_dot2c_f32_bf16 v199, v5, v48
  v_dot2c_f32_bf16 v206, v4, v50
  v_dot2c_f32_bf16 v207, v5, v50
  v_perm_b32 v4, v220, v216, s36
  v_perm_b32 v5, v220, v216, s37
  v_dot2c_f32_bf16 v192, v4, v49
  v_dot2c_f32_bf16 v193, v5, v49
  v_dot2c_f32_bf16 v200, v4, v51
  v_dot2c_f32_bf16 v201, v5, v51
  v_perm_b32 v4, v221, v217, s36
  v_perm_b32 v5, v221, v217, s37
  v_dot2c_f32_bf16 v194, v4, v49
  v_dot2c_f32_bf16 v195, v5, v49
  v_dot2c_f32_bf16 v202, v4, v51
  v_dot2c_f32_bf16 v203, v5, v51
  v_perm_b32 v4, v222, v218, s36
  v_perm_b32 v5, v222, v218, s37
  v_dot2c_f32_bf16 v196, v4, v49
  v_dot2c_f32_bf16 v197, v5, v49
  v_dot2c_f32_bf16 v204, v4, v51
  v_dot2c_f32_bf16 v205, v5, v51
  v_perm_b32 v4, v223, v219, s36
  v_perm_b32 v5, v223, v219, s37
  v_dot2c_f32_bf16 v198, v4, v49
  v_dot2c_f32_bf16 v199, v5, v49
  v_dot2c_f32_bf16 v206, v4, v51
  v_dot2c_f32_bf16 v207, v5, v51
  s_nop 2
  s_lshl_b32 s40, s33, 12
  v_lshlrev_b32 v10, 7, v12
  v_lshlrev_b32 v11, 5, v13
  v_add_u32 v10, v10, v11
  v_add_u32 v10, s40, v10
  ds_write_b128 v10, v[16:19] offset:0
  ds_write_b128 v10, v[20:23] offset:16
  ds_write_b128 v10, v[24:27] offset:64
  ds_write_b128 v10, v[28:31] offset:80
  ds_write_b128 v10, v[192:195] offset:16384
  ds_write_b128 v10, v[196:199] offset:16400
  ds_write_b128 v10, v[200:203] offset:16448
  ds_write_b128 v10, v[204:207] offset:16464
  s_waitcnt lgkmcnt(0)
  s_barrier
  v_lshrrev_b32 v10, 7, v0
  v_lshlrev_b32 v10, 14, v10
  v_lshrrev_b32 v11, 5, v0
  v_and_b32 v11, 3, v11
  v_lshlrev_b32 v11, 12, v11
  v_add_u32 v10, v10, v11
  v_and_b32 v11, 31, v0
  v_lshlrev_b32 v11, 2, v11
  v_add_u32 v10, v10, v11
  ds_read_b32 v16, v10 offset:0
  ds_read_b32 v17, v10 offset:128
  ds_read_b32 v18, v10 offset:256
  ds_read_b32 v19, v10 offset:384
  ds_read_b32 v20, v10 offset:512
  ds_read_b32 v21, v10 offset:640
  ds_read_b32 v22, v10 offset:768
  ds_read_b32 v23, v10 offset:896
  ds_read_b32 v24, v10 offset:1024
  ds_read_b32 v25, v10 offset:1152
  ds_read_b32 v26, v10 offset:1280
  ds_read_b32 v27, v10 offset:1408
  ds_read_b32 v28, v10 offset:1536
  ds_read_b32 v29, v10 offset:1664
  ds_read_b32 v30, v10 offset:1792
  ds_read_b32 v31, v10 offset:1920
  ds_read_b32 v192, v10 offset:2048
  ds_read_b32 v193, v10 offset:2176
  ds_read_b32 v194, v10 offset:2304
  ds_read_b32 v195, v10 offset:2432
  ds_read_b32 v196, v10 offset:2560
  ds_read_b32 v197, v10 offset:2688
  ds_read_b32 v198, v10 offset:2816
  ds_read_b32 v199, v10 offset:2944
  ds_read_b32 v200, v10 offset:3072
  ds_read_b32 v201, v10 offset:3200
  ds_read_b32 v202, v10 offset:3328
  ds_read_b32 v203, v10 offset:3456
  ds_read_b32 v204, v10 offset:3584
  ds_read_b32 v205, v10 offset:3712
  ds_read_b32 v206, v10 offset:3840
  ds_read_b32 v207, v10 offset:3968
  s_waitcnt lgkmcnt(0)
  v_add_f32 v16, v16, v192
  v_add_f32 v17, v17, v193
  v_add_f32 v18, v18, v194
  v_add_f32 v19, v19, v195
  v_add_f32 v20, v20, v196
  v_add_f32 v21, v21, v197
  v_add_f32 v22, v22, v198
  v_add_f32 v23, v23, v199
  v_add_f32 v24, v24, v200
  v_add_f32 v25, v25, v201
  v_add_f32 v26, v26, v202
  v_add_f32 v27, v27, v203
  v_add_f32 v28, v28, v204
  v_add_f32 v29, v29, v205
  v_add_f32 v30, v30, v206
  v_add_f32 v31, v31, v207
  v_add_f32 v16, v16, v24
  v_add_f32 v17, v17, v25
  v_add_f32 v18, v18, v26
  v_add_f32 v19, v19, v27
  v_add_f32 v20, v20, v28
  v_add_f32 v21, v21, v29
  v_add_f32 v22, v22, v30
  v_add_f32 v23, v23, v31
  v_add_f32 v16, v16, v20
  v_add_f32 v17, v17, v21
  v_add_f32 v18, v18, v22
  v_add_f32 v19, v19, v23
  v_add_f32 v16, v16, v18
  v_add_f32 v17, v17, v19
  v_add_f32 v16, v16, v17
  v_lshlrev_b32 v10, 2, v0
  ds_write_b32 v10, v16 offset:36864
  s_waitcnt lgkmcnt(0)
  s_barrier
  v_cmp_gt_u32 vcc, 32, v0
  s_and_saveexec_b64 s[48:49], vcc
  s_cbranch_execz Lffn32_3
  v_lshlrev_b32 v10, 2, v0
  ds_read_b32 v16, v10 offset:36864
  ds_read_b32 v17, v10 offset:36992
  ds_read_b32 v18, v10 offset:37120
  ds_read_b32 v19, v10 offset:37248
  ds_read_b32 v20, v10 offset:37376
  ds_read_b32 v21, v10 offset:37504
  ds_read_b32 v22, v10 offset:37632
  ds_read_b32 v23, v10 offset:37760
  s_waitcnt lgkmcnt(0)
  v_add_f32 v4, v16, v17
  v_add_f32 v4, v4, v18
  v_add_f32 v4, v4, v19
  v_add_f32 v5, v20, v21
  v_add_f32 v5, v5, v22
  v_add_f32 v5, v5, v23
  v_mul_f32 v6, v4, v4
  s_mov_b32 s40, 0x3d122279
  v_mov_b32 v7, 0x3f4c422a
  v_fma_f32 v6, v6, s40, v7
  v_mul_f32 v6, v6, v4
  v_mul_f32 v6, 0x4038aa3b, v6
  v_exp_f32 v6, v6
  s_nop 0
  v_add_f32 v6, 1.0, v6
  v_rcp_f32 v6, v6
  s_nop 0
  v_sub_f32 v6, 1.0, v6
  v_mul_f32 v6, v6, v4
  v_mul_f32 v6, v6, v5
  v_cvt_pk_bf16_f32 v6, v6, v6
  v_lshlrev_b32 v10, 1, v0
  ds_write_b16 v10, v6 offset:34304
Lffn32_3:
  s_mov_b64 exec, s[48:49]
  s_waitcnt lgkmcnt(0)
  s_barrier
  s_lshl_b32 s40, s33, 3
  v_mov_b32 v10, s40
  ds_read_b64 v[48:49], v10 offset:34304
  ds_read_b64 v[50:51], v10 offset:34336
  v_mov_b32 v16, 0
  v_mov_b32 v17, 0
  v_mov_b32 v18, 0
  v_mov_b32 v19, 0
  v_mov_b32 v20, 0
  v_mov_b32 v21, 0
  v_mov_b32 v22, 0
  v_mov_b32 v23, 0
  v_mov_b32 v24, 0
  v_mov_b32 v25, 0
  v_mov_b32 v26, 0
  v_mov_b32 v27, 0
  v_mov_b32 v28, 0
  v_mov_b32 v29, 0
  v_mov_b32 v30, 0
  v_mov_b32 v31, 0
  s_waitcnt lgkmcnt(0)
  v_perm_b32 v4, v36, v32, s36
  v_perm_b32 v5, v36, v32, s37
  v_dot2c_f32_bf16 v16, v4, v48
  v_dot2c_f32_bf16 v17, v5, v48
  v_dot2c_f32_bf16 v24, v4, v50
  v_dot2c_f32_bf16 v25, v5, v50
  v_perm_b32 v4, v37, v33, s36
  v_perm_b32 v5, v37, v33, s37
  v_dot2c_f32_bf16 v18, v4, v48
  v_dot2c_f32_bf16 v19, v5, v48
  v_dot2c_f32_bf16 v26, v4, v50
  v_dot2c_f32_bf16 v27, v5, v50
  v_perm_b32 v4, v38, v34, s36
  v_perm_b32 v5, v38, v34, s37
  v_dot2c_f32_bf16 v20, v4, v48
  v_dot2c_f32_bf16 v21, v5, v48
  v_dot2c_f32_bf16 v28, v4, v50
  v_dot2c_f32_bf16 v29, v5, v50
  v_perm_b32 v4, v39, v35, s36
  v_perm_b32 v5, v39, v35, s37
  v_dot2c_f32_bf16 v22, v4, v48
  v_dot2c_f32_bf16 v23, v5, v48
  v_dot2c_f32_bf16 v30, v4, v50
  v_dot2c_f32_bf16 v31, v5, v50
  v_perm_b32 v4, v44, v40, s36
  v_perm_b32 v5, v44, v40, s37
  v_dot2c_f32_bf16 v16, v4, v49
  v_dot2c_f32_bf16 v17, v5, v49
  v_dot2c_f32_bf16 v24, v4, v51
  v_dot2c_f32_bf16 v25, v5, v51
  v_perm_b32 v4, v45, v41, s36
  v_perm_b32 v5, v45, v41, s37
  v_dot2c_f32_bf16 v18, v4, v49
  v_dot2c_f32_bf16 v19, v5, v49
  v_dot2c_f32_bf16 v26, v4, v51
  v_dot2c_f32_bf16 v27, v5, v51
  v_perm_b32 v4, v46, v42, s36
  v_perm_b32 v5, v46, v42, s37
  v_dot2c_f32_bf16 v20, v4, v49
  v_dot2c_f32_bf16 v21, v5, v49
  v_dot2c_f32_bf16 v28, v4, v51
  v_dot2c_f32_bf16 v29, v5, v51
  v_perm_b32 v4, v47, v43, s36
  v_perm_b32 v5, v47, v43, s37
  v_dot2c_f32_bf16 v22, v4, v49
  v_dot2c_f32_bf16 v23, v5, v49
  v_dot2c_f32_bf16 v30, v4, v51
  v_dot2c_f32_bf16 v31, v5, v51
  s_nop 2
  s_add_u32 s44, s52, 128
  s_lshl_b32 s40, s33, 12
  v_lshlrev_b32 v10, 5, v1
  v_add_u32 v10, s40, v10
  s_nop 1
  ds_write_b128 v10, v[16:19] offset:0
  ds_write_b128 v10, v[20:23] offset:16
  ds_write_b128 v10, v[24:27] offset:2048
  ds_write_b128 v10, v[28:31] offset:2064
  s_waitcnt lgkmcnt(0)
  s_barrier
  v_lshlrev_b32 v10, 4, v0
  ds_read_b128 v[16:19], v10 offset:0
  ds_read_b128 v[20:23], v10 offset:4096
  ds_read_b128 v[24:27], v10 offset:8192
  ds_read_b128 v[28:31], v10 offset:12288
  s_waitcnt lgkmcnt(0)
  v_add_f32 v16, v16, v20
  v_add_f32 v24, v24, v28
  v_add_f32 v17, v17, v21
  v_add_f32 v25, v25, v29
  v_add_f32 v18, v18, v22
  v_add_f32 v26, v26, v30
  v_add_f32 v19, v19, v23
  v_add_f32 v27, v27, v31
  v_add_f32 v16, v16, v24
  v_min_u32 v16, -2, v16
  v_add_f32 v17, v17, v25
  v_min_u32 v17, -2, v17
  v_add_f32 v18, v18, v26
  v_min_u32 v18, -2, v18
  v_add_f32 v19, v19, v27
  v_min_u32 v19, -2, v19
  s_lshl_b32 s40, s44, 12
  s_add_u32 s40, s40, 262144
  v_add_u32 v10, s40, v10
  global_store_dwordx4 v10, v[16:19], s[30:31] sc1
  s_barrier
  s_waitcnt vmcnt(0)
  v_perm_b32 v4, v228, v224, s36
  v_perm_b32 v228, v228, v224, s37
  v_mov_b32 v224, v4
  v_perm_b32 v4, v229, v225, s36
  v_perm_b32 v229, v229, v225, s37
  v_mov_b32 v225, v4
  v_perm_b32 v4, v230, v226, s36
  v_perm_b32 v230, v230, v226, s37
  v_mov_b32 v226, v4
  v_perm_b32 v4, v231, v227, s36
  v_perm_b32 v231, v231, v227, s37
  v_mov_b32 v227, v4
  v_perm_b32 v4, v236, v232, s36
  v_perm_b32 v236, v236, v232, s37
  v_mov_b32 v232, v4
  v_perm_b32 v4, v237, v233, s36
  v_perm_b32 v237, v237, v233, s37
  v_mov_b32 v233, v4
  v_perm_b32 v4, v238, v234, s36
  v_perm_b32 v238, v238, v234, s37
  v_mov_b32 v234, v4
  v_perm_b32 v4, v239, v235, s36
  v_perm_b32 v239, v239, v235, s37
  v_mov_b32 v235, v4
  v_perm_b32 v4, v244, v240, s36
  v_perm_b32 v244, v244, v240, s37
  v_mov_b32 v240, v4
  v_perm_b32 v4, v245, v241, s36
  v_perm_b32 v245, v245, v241, s37
  v_mov_b32 v241, v4
  v_perm_b32 v4, v246, v242, s36
  v_perm_b32 v246, v246, v242, s37
  v_mov_b32 v242, v4
  v_perm_b32 v4, v247, v243, s36
  v_perm_b32 v247, v247, v243, s37
  v_mov_b32 v243, v4
  v_perm_b32 v4, v252, v248, s36
  v_perm_b32 v252, v252, v248, s37
  v_mov_b32 v248, v4
  v_perm_b32 v4, v253, v249, s36
  v_perm_b32 v253, v253, v249, s37
  v_mov_b32 v249, v4
  v_perm_b32 v4, v254, v250, s36
  v_perm_b32 v254, v254, v250, s37
  v_mov_b32 v250, v4
  v_perm_b32 v4, v255, v251, s36
  v_perm_b32 v255, v255, v251, s37
  v_mov_b32 v251, v4
  v_perm_b32 v4, v68, v64, s36
  v_perm_b32 v68, v68, v64, s37
  v_mov_b32 v64, v4
  v_perm_b32 v4, v69, v65, s36
  v_perm_b32 v69, v69, v65, s37
  v_mov_b32 v65, v4
  v_perm_b32 v4, v70, v66, s36
  v_perm_b32 v70, v70, v66, s37
  v_mov_b32 v66, v4
  v_perm_b32 v4, v71, v67, s36
  v_perm_b32 v71, v71, v67, s37
  v_mov_b32 v67, v4
  v_perm_b32 v4, v76, v72, s36
  v_perm_b32 v76, v76, v72, s37
  v_mov_b32 v72, v4
  v_perm_b32 v4, v77, v73, s36
  v_perm_b32 v77, v77, v73, s37
  v_mov_b32 v73, v4
  v_perm_b32 v4, v78, v74, s36
  v_perm_b32 v78, v78, v74, s37
  v_mov_b32 v74, v4
  v_perm_b32 v4, v79, v75, s36
  v_perm_b32 v79, v79, v75, s37
  v_mov_b32 v75, v4
  v_perm_b32 v4, v84, v80, s36
  v_perm_b32 v84, v84, v80, s37
  v_mov_b32 v80, v4
  v_perm_b32 v4, v85, v81, s36
  v_perm_b32 v85, v85, v81, s37
  v_mov_b32 v81, v4
  v_perm_b32 v4, v86, v82, s36
  v_perm_b32 v86, v86, v82, s37
  v_mov_b32 v82, v4
  v_perm_b32 v4, v87, v83, s36
  v_perm_b32 v87, v87, v83, s37
  v_mov_b32 v83, v4
  v_perm_b32 v4, v92, v88, s36
  v_perm_b32 v92, v92, v88, s37
  v_mov_b32 v88, v4
  v_perm_b32 v4, v93, v89, s36
  v_perm_b32 v93, v93, v89, s37
  v_mov_b32 v89, v4
  v_perm_b32 v4, v94, v90, s36
  v_perm_b32 v94, v94, v90, s37
  v_mov_b32 v90, v4
  v_perm_b32 v4, v95, v91, s36
  v_perm_b32 v95, v95, v91, s37
  v_mov_b32 v91, v4
  v_perm_b32 v4, v100, v96, s36
  v_perm_b32 v100, v100, v96, s37
  v_mov_b32 v96, v4
  v_perm_b32 v4, v101, v97, s36
  v_perm_b32 v101, v101, v97, s37
  v_mov_b32 v97, v4
  v_perm_b32 v4, v102, v98, s36
  v_perm_b32 v102, v102, v98, s37
  v_mov_b32 v98, v4
  v_perm_b32 v4, v103, v99, s36
  v_perm_b32 v103, v103, v99, s37
  v_mov_b32 v99, v4
  v_perm_b32 v4, v108, v104, s36
  v_perm_b32 v108, v108, v104, s37
  v_mov_b32 v104, v4
  v_perm_b32 v4, v109, v105, s36
  v_perm_b32 v109, v109, v105, s37
  v_mov_b32 v105, v4
  v_perm_b32 v4, v110, v106, s36
  v_perm_b32 v110, v110, v106, s37
  v_mov_b32 v106, v4
  v_perm_b32 v4, v111, v107, s36
  v_perm_b32 v111, v111, v107, s37
  v_mov_b32 v107, v4
  v_perm_b32 v4, v116, v112, s36
  v_perm_b32 v116, v116, v112, s37
  v_mov_b32 v112, v4
  v_perm_b32 v4, v117, v113, s36
  v_perm_b32 v117, v117, v113, s37
  v_mov_b32 v113, v4
  v_perm_b32 v4, v118, v114, s36
  v_perm_b32 v118, v118, v114, s37
  v_mov_b32 v114, v4
  v_perm_b32 v4, v119, v115, s36
  v_perm_b32 v119, v119, v115, s37
  v_mov_b32 v115, v4
  v_perm_b32 v4, v124, v120, s36
  v_perm_b32 v124, v124, v120, s37
  v_mov_b32 v120, v4
  v_perm_b32 v4, v125, v121, s36
  v_perm_b32 v125, v125, v121, s37
  v_mov_b32 v121, v4
  v_perm_b32 v4, v126, v122, s36
  v_perm_b32 v126, v126, v122, s37
  v_mov_b32 v122, v4
  v_perm_b32 v4, v127, v123, s36
  v_perm_b32 v127, v127, v123, s37
  v_mov_b32 v123, v4
  v_perm_b32 v4, v132, v128, s36
  v_perm_b32 v132, v132, v128, s37
  v_mov_b32 v128, v4
  v_perm_b32 v4, v133, v129, s36
  v_perm_b32 v133, v133, v129, s37
  v_mov_b32 v129, v4
  v_perm_b32 v4, v134, v130, s36
  v_perm_b32 v134, v134, v130, s37
  v_mov_b32 v130, v4
  v_perm_b32 v4, v135, v131, s36
  v_perm_b32 v135, v135, v131, s37
  v_mov_b32 v131, v4
  v_perm_b32 v4, v140, v136, s36
  v_perm_b32 v140, v140, v136, s37
  v_mov_b32 v136, v4
  v_perm_b32 v4, v141, v137, s36
  v_perm_b32 v141, v141, v137, s37
  v_mov_b32 v137, v4
  v_perm_b32 v4, v142, v138, s36
  v_perm_b32 v142, v142, v138, s37
  v_mov_b32 v138, v4
  v_perm_b32 v4, v143, v139, s36
  v_perm_b32 v143, v143, v139, s37
  v_mov_b32 v139, v4
  v_perm_b32 v4, v148, v144, s36
  v_perm_b32 v148, v148, v144, s37
  v_mov_b32 v144, v4
  v_perm_b32 v4, v149, v145, s36
  v_perm_b32 v149, v149, v145, s37
  v_mov_b32 v145, v4
  v_perm_b32 v4, v150, v146, s36
  v_perm_b32 v150, v150, v146, s37
  v_mov_b32 v146, v4
  v_perm_b32 v4, v151, v147, s36
  v_perm_b32 v151, v151, v147, s37
  v_mov_b32 v147, v4
  v_perm_b32 v4, v156, v152, s36
  v_perm_b32 v156, v156, v152, s37
  v_mov_b32 v152, v4
  v_perm_b32 v4, v157, v153, s36
  v_perm_b32 v157, v157, v153, s37
  v_mov_b32 v153, v4
  v_perm_b32 v4, v158, v154, s36
  v_perm_b32 v158, v158, v154, s37
  v_mov_b32 v154, v4
  v_perm_b32 v4, v159, v155, s36
  v_perm_b32 v159, v159, v155, s37
  v_mov_b32 v155, v4
  v_perm_b32 v4, v164, v160, s36
  v_perm_b32 v164, v164, v160, s37
  v_mov_b32 v160, v4
  v_perm_b32 v4, v165, v161, s36
  v_perm_b32 v165, v165, v161, s37
  v_mov_b32 v161, v4
  v_perm_b32 v4, v166, v162, s36
  v_perm_b32 v166, v166, v162, s37
  v_mov_b32 v162, v4
  v_perm_b32 v4, v167, v163, s36
  v_perm_b32 v167, v167, v163, s37
  v_mov_b32 v163, v4
  v_perm_b32 v4, v172, v168, s36
  v_perm_b32 v172, v172, v168, s37
  v_mov_b32 v168, v4
  v_perm_b32 v4, v173, v169, s36
  v_perm_b32 v173, v173, v169, s37
  v_mov_b32 v169, v4
  v_perm_b32 v4, v174, v170, s36
  v_perm_b32 v174, v174, v170, s37
  v_mov_b32 v170, v4
  v_perm_b32 v4, v175, v171, s36
  v_perm_b32 v175, v175, v171, s37
  v_mov_b32 v171, v4
  v_perm_b32 v4, v180, v176, s36
  v_perm_b32 v180, v180, v176, s37
  v_mov_b32 v176, v4
  v_perm_b32 v4, v181, v177, s36
  v_perm_b32 v181, v181, v177, s37
  v_mov_b32 v177, v4
  v_perm_b32 v4, v182, v178, s36
  v_perm_b32 v182, v182, v178, s37
  v_mov_b32 v178, v4
  v_perm_b32 v4, v183, v179, s36
  v_perm_b32 v183, v183, v179, s37
  v_mov_b32 v179, v4
  v_perm_b32 v4, v188, v184, s36
  v_perm_b32 v188, v188, v184, s37
  v_mov_b32 v184, v4
  v_perm_b32 v4, v189, v185, s36
  v_perm_b32 v189, v189, v185, s37
  v_mov_b32 v185, v4
  v_perm_b32 v4, v190, v186, s36
  v_perm_b32 v190, v190, v186, s37
  v_mov_b32 v186, v4
  v_perm_b32 v4, v191, v187, s36
  v_perm_b32 v191, v191, v187, s37
  v_mov_b32 v187, v4
  s_lshr_b32 s50, s33, 1
  s_and_b32 s51, s33, 1
  s_lshl_b32 s40, s50, 5
  s_add_u32 s40, s40, s34
  s_lshl_b32 s41, s40, 9
  v_lshlrev_b32 v12, 3, v1
  v_add_u32 v12, s41, v12
  s_lshl_b32 s41, s40, 16
  s_lshl_b32 s42, s51, 15
  s_add_u32 s41, s41, s42
  s_lshl_b32 s42, s35, 8
  s_add_u32 s41, s41, s42
  s_add_u32 s41, s41, 1310720
  v_lshlrev_b32 v13, 10, v2
  v_lshlrev_b32 v11, 4, v3
  v_add_u32 v13, v13, v11
  v_add_u32 v13, s41, v13
  v_add_u32 v12, 65536, v12
  s_mov_b32 s38, 200000
Lp_4:
  global_load_dwordx2 v[48:49], v12, s[30:31] sc1
  s_waitcnt vmcnt(0)
  v_max_u32 v4, v48, v49
  v_cmp_eq_u32 vcc, -1, v4
  s_cbranch_vccz Lpd_5
  s_sub_u32 s38, s38, 1
  s_cmp_eq_u32 s38, 0
  s_cbranch_scc1 Lpd_5
  s_sleep 1
  s_branch Lp_4
Lpd_5:
  global_load_dwordx4 v[192:195], v13, s[30:31] sc1
  v_add_u32 v13, 0x1000, v13
  global_load_dwordx4 v[196:199], v13, s[30:31] sc1
  v_add_u32 v13, 0x1000, v13
  global_load_dwordx4 v[200:203], v13, s[30:31] sc1
  v_add_u32 v13, 0x1000, v13
  global_load_dwordx4 v[204:207], v13, s[30:31] sc1
  v_add_u32 v13, 0x1000, v13
  global_load_dwordx4 v[208:211], v13, s[30:31] sc1
  v_add_u32 v13, 0x1000, v13
  global_load_dwordx4 v[212:215], v13, s[30:31] sc1
  v_add_u32 v13, 0x1000, v13
  global_load_dwordx4 v[216:219], v13, s[30:31] sc1
  v_add_u32 v13, 0x1000, v13
  global_load_dwordx4 v[220:223], v13, s[30:31] sc1
  v_mov_b32 v50, v48
  s_nop 1
  v_max_f32_dpp v50, v50, v50 quad_perm:[1,0,3,2] row_mask:0xf bank_mask:0xf
  s_nop 1
  v_max_f32_dpp v50, v50, v50 quad_perm:[2,3,0,1] row_mask:0xf bank_mask:0xf
  s_nop 1
  v_max_f32_dpp v50, v50, v50 row_half_mirror row_mask:0xf bank_mask:0xf
  s_nop 1
  v_max_f32_dpp v50, v50, v50 row_mirror row_mask:0xf bank_mask:0xf
  v_mov_b32 v51, v50
  s_nop 1
  v_permlane16_swap_b32 v50, v51
  s_nop 1
  v_max_f32 v50, v50, v51
  v_mov_b32 v51, v50
  s_nop 1
  v_permlane32_swap_b32 v50, v51
  s_nop 1
  v_max_f32 v50, v50, v51
  v_sub_f32 v50, v48, v50
  v_exp_f32 v50, v50
  s_nop 0
  v_mul_f32 v52, v50, v49
  s_nop 1
  v_add_f32_dpp v52, v52, v52 quad_perm:[1,0,3,2] row_mask:0xf bank_mask:0xf
  s_nop 1
  v_add_f32_dpp v52, v52, v52 quad_perm:[2,3,0,1] row_mask:0xf bank_mask:0xf
  s_nop 1
  v_add_f32_dpp v52, v52, v52 row_half_mirror row_mask:0xf bank_mask:0xf
  s_nop 1
  v_add_f32_dpp v52, v52, v52 row_mirror row_mask:0xf bank_mask:0xf
  v_mov_b32 v51, v52
  s_nop 1
  v_permlane16_swap_b32 v52, v51
  s_nop 1
  v_add_f32 v52, v52, v51
  v_mov_b32 v51, v52
  s_nop 1
  v_permlane32_swap_b32 v52, v51
  s_nop 1
  v_add_f32 v52, v52, v51
  v_rcp_f32 v52, v52
  s_nop 0
  v_mul_f32 v50, v50, v52
  s_lshl_b32 s40, s51, 7
  v_lshlrev_b32 v10, 2, v2
  v_add_u32 v10, s40, v10
  ds_bpermute_b32 v52, v10, v50 offset:0
  ds_bpermute_b32 v53, v10, v50 offset:16
  ds_bpermute_b32 v54, v10, v50 offset:32
  ds_bpermute_b32 v55, v10, v50 offset:48
  ds_bpermute_b32 v56, v10, v50 offset:64
  ds_bpermute_b32 v57, v10, v50 offset:80
  ds_bpermute_b32 v58, v10, v50 offset:96
  ds_bpermute_b32 v59, v10, v50 offset:112
  v_mov_b32 v16, 0
  v_mov_b32 v17, 0
  v_mov_b32 v18, 0
  v_mov_b32 v19, 0
  v_mov_b32 v20, 0
  v_mov_b32 v21, 0
  v_mov_b32 v22, 0
  v_mov_b32 v23, 0
  s_waitcnt lgkmcnt(0)
  s_waitcnt vmcnt(0)
  v_lshlrev_b32 v4, 16, v192
  v_and_b32 v5, 0xffff0000, v192
  v_fmac_f32 v16, v52, v4
  v_fmac_f32 v17, v52, v5
  v_lshlrev_b32 v4, 16, v193
  v_and_b32 v5, 0xffff0000, v193
  v_fmac_f32 v18, v52, v4
  v_fmac_f32 v19, v52, v5
  v_lshlrev_b32 v4, 16, v194
  v_and_b32 v5, 0xffff0000, v194
  v_fmac_f32 v20, v52, v4
  v_fmac_f32 v21, v52, v5
  v_lshlrev_b32 v4, 16, v195
  v_and_b32 v5, 0xffff0000, v195
  v_fmac_f32 v22, v52, v4
  v_fmac_f32 v23, v52, v5
  v_lshlrev_b32 v4, 16, v196
  v_and_b32 v5, 0xffff0000, v196
  v_fmac_f32 v16, v53, v4
  v_fmac_f32 v17, v53, v5
  v_lshlrev_b32 v4, 16, v197
  v_and_b32 v5, 0xffff0000, v197
  v_fmac_f32 v18, v53, v4
  v_fmac_f32 v19, v53, v5
  v_lshlrev_b32 v4, 16, v198
  v_and_b32 v5, 0xffff0000, v198
  v_fmac_f32 v20, v53, v4
  v_fmac_f32 v21, v53, v5
  v_lshlrev_b32 v4, 16, v199
  v_and_b32 v5, 0xffff0000, v199
  v_fmac_f32 v22, v53, v4
  v_fmac_f32 v23, v53, v5
  v_lshlrev_b32 v4, 16, v200
  v_and_b32 v5, 0xffff0000, v200
  v_fmac_f32 v16, v54, v4
  v_fmac_f32 v17, v54, v5
  v_lshlrev_b32 v4, 16, v201
  v_and_b32 v5, 0xffff0000, v201
  v_fmac_f32 v18, v54, v4
  v_fmac_f32 v19, v54, v5
  v_lshlrev_b32 v4, 16, v202
  v_and_b32 v5, 0xffff0000, v202
  v_fmac_f32 v20, v54, v4
  v_fmac_f32 v21, v54, v5
  v_lshlrev_b32 v4, 16, v203
  v_and_b32 v5, 0xffff0000, v203
  v_fmac_f32 v22, v54, v4
  v_fmac_f32 v23, v54, v5
  v_lshlrev_b32 v4, 16, v204
  v_and_b32 v5, 0xffff0000, v204
  v_fmac_f32 v16, v55, v4
  v_fmac_f32 v17, v55, v5
  v_lshlrev_b32 v4, 16, v205
  v_and_b32 v5, 0xffff0000, v205
  v_fmac_f32 v18, v55, v4
  v_fmac_f32 v19, v55, v5
  v_lshlrev_b32 v4, 16, v206
  v_and_b32 v5, 0xffff0000, v206
  v_fmac_f32 v20, v55, v4
  v_fmac_f32 v21, v55, v5
  v_lshlrev_b32 v4, 16, v207
  v_and_b32 v5, 0xffff0000, v207
  v_fmac_f32 v22, v55, v4
  v_fmac_f32 v23, v55, v5
  v_lshlrev_b32 v4, 16, v208
  v_and_b32 v5, 0xffff0000, v208
  v_fmac_f32 v16, v56, v4
  v_fmac_f32 v17, v56, v5
  v_lshlrev_b32 v4, 16, v209
  v_and_b32 v5, 0xffff0000, v209
  v_fmac_f32 v18, v56, v4
  v_fmac_f32 v19, v56, v5
  v_lshlrev_b32 v4, 16, v210
  v_and_b32 v5, 0xffff0000, v210
  v_fmac_f32 v20, v56, v4
  v_fmac_f32 v21, v56, v5
  v_lshlrev_b32 v4, 16, v211
  v_and_b32 v5, 0xffff0000, v211
  v_fmac_f32 v22, v56, v4
  v_fmac_f32 v23, v56, v5
  v_lshlrev_b32 v4, 16, v212
  v_and_b32 v5, 0xffff0000, v212
  v_fmac_f32 v16, v57, v4
  v_fmac_f32 v17, v57, v5
  v_lshlrev_b32 v4, 16, v213
  v_and_b32 v5, 0xffff0000, v213
  v_fmac_f32 v18, v57, v4
  v_fmac_f32 v19, v57, v5
  v_lshlrev_b32 v4, 16, v214
  v_and_b32 v5, 0xffff0000, v214
  v_fmac_f32 v20, v57, v4
  v_fmac_f32 v21, v57, v5
  v_lshlrev_b32 v4, 16, v215
  v_and_b32 v5, 0xffff0000, v215
  v_fmac_f32 v22, v57, v4
  v_fmac_f32 v23, v57, v5
  v_lshlrev_b32 v4, 16, v216
  v_and_b32 v5, 0xffff0000, v216
  v_fmac_f32 v16, v58, v4
  v_fmac_f32 v17, v58, v5
  v_lshlrev_b32 v4, 16, v217
  v_and_b32 v5, 0xffff0000, v217
  v_fmac_f32 v18, v58, v4
  v_fmac_f32 v19, v58, v5
  v_lshlrev_b32 v4, 16, v218
  v_and_b32 v5, 0xffff0000, v218
  v_fmac_f32 v20, v58, v4
  v_fmac_f32 v21, v58, v5
  v_lshlrev_b32 v4, 16, v219
  v_and_b32 v5, 0xffff0000, v219
  v_fmac_f32 v22, v58, v4
  v_fmac_f32 v23, v58, v5
  v_lshlrev_b32 v4, 16, v220
  v_and_b32 v5, 0xffff0000, v220
  v_fmac_f32 v16, v59, v4
  v_fmac_f32 v17, v59, v5
  v_lshlrev_b32 v4, 16, v221
  v_and_b32 v5, 0xffff0000, v221
  v_fmac_f32 v18, v59, v4
  v_fmac_f32 v19, v59, v5
  v_lshlrev_b32 v4, 16, v222
  v_and_b32 v5, 0xffff0000, v222
  v_fmac_f32 v20, v59, v4
  v_fmac_f32 v21, v59, v5
  v_lshlrev_b32 v4, 16, v223
  v_and_b32 v5, 0xffff0000, v223
  v_fmac_f32 v22, v59, v4
  v_fmac_f32 v23, v59, v5
  s_lshl_b32 s40, s33, 11
  v_lshlrev_b32 v10, 9, v2
  v_lshlrev_b32 v11, 5, v3
  v_add_u32 v10, v10, v11
  v_add_u32 v10, s40, v10
  ds_write_b128 v10, v[16:19] offset:0
  ds_write_b128 v10, v[20:23] offset:16
  s_waitcnt lgkmcnt(0)
  s_barrier
  v_lshrrev_b32 v10, 7, v0
  v_lshlrev_b32 v10, 12, v10
  v_and_b32 v11, 127, v0
  v_lshlrev_b32 v11, 2, v11
  v_add_u32 v10, v10, v11
  ds_read_b32 v48, v10 offset:0
  ds_read_b32 v49, v10 offset:512
  ds_read_b32 v50, v10 offset:1024
  ds_read_b32 v51, v10 offset:1536
  ds_read_b32 v52, v10 offset:2048
  ds_read_b32 v53, v10 offset:2560
  ds_read_b32 v54, v10 offset:3072
  ds_read_b32 v55, v10 offset:3584
  s_waitcnt lgkmcnt(0)
  v_add_f32 v48, v48, v52
  v_add_f32 v49, v49, v53
  v_add_f32 v50, v50, v54
  v_add_f32 v51, v51, v55
  v_add_f32 v48, v48, v50
  v_add_f32 v49, v49, v51
  v_add_f32 v48, v48, v49
  v_cvt_pk_bf16_f32 v48, v48, v48
  v_lshlrev_b32 v10, 1, v0
  ds_write_b16 v10, v48 offset:33280
  s_waitcnt lgkmcnt(0)
  s_barrier
  s_lshl_b32 s40, s33, 6
  v_lshlrev_b32 v10, 4, v2
  v_add_u32 v10, s40, v10
  ds_read_b128 v[48:51], v10 offset:33280
  ds_read_b128 v[52:55], v10 offset:33536
  v_mov_b32 v16, 0
  v_mov_b32 v17, 0
  v_mov_b32 v18, 0
  v_mov_b32 v19, 0
  v_mov_b32 v20, 0
  v_mov_b32 v21, 0
  v_mov_b32 v22, 0
  v_mov_b32 v23, 0
  v_mov_b32 v24, 0
  v_mov_b32 v25, 0
  v_mov_b32 v26, 0
  v_mov_b32 v27, 0
  v_mov_b32 v28, 0
  v_mov_b32 v29, 0
  v_mov_b32 v30, 0
  v_mov_b32 v31, 0
  s_waitcnt lgkmcnt(0)
  v_dot2c_f32_bf16 v16, v224, v48
  v_dot2c_f32_bf16 v17, v228, v48
  v_dot2c_f32_bf16 v24, v224, v52
  v_dot2c_f32_bf16 v25, v228, v52
  v_dot2c_f32_bf16 v18, v225, v48
  v_dot2c_f32_bf16 v19, v229, v48
  v_dot2c_f32_bf16 v26, v225, v52
  v_dot2c_f32_bf16 v27, v229, v52
  v_dot2c_f32_bf16 v20, v226, v48
  v_dot2c_f32_bf16 v21, v230, v48
  v_dot2c_f32_bf16 v28, v226, v52
  v_dot2c_f32_bf16 v29, v230, v52
  v_dot2c_f32_bf16 v22, v227, v48
  v_dot2c_f32_bf16 v23, v231, v48
  v_dot2c_f32_bf16 v30, v227, v52
  v_dot2c_f32_bf16 v31, v231, v52
  v_dot2c_f32_bf16 v16, v232, v49
  v_dot2c_f32_bf16 v17, v236, v49
  v_dot2c_f32_bf16 v24, v232, v53
  v_dot2c_f32_bf16 v25, v236, v53
  v_dot2c_f32_bf16 v18, v233, v49
  v_dot2c_f32_bf16 v19, v237, v49
  v_dot2c_f32_bf16 v26, v233, v53
  v_dot2c_f32_bf16 v27, v237, v53
  v_dot2c_f32_bf16 v20, v234, v49
  v_dot2c_f32_bf16 v21, v238, v49
  v_dot2c_f32_bf16 v28, v234, v53
  v_dot2c_f32_bf16 v29, v238, v53
  v_dot2c_f32_bf16 v22, v235, v49
  v_dot2c_f32_bf16 v23, v239, v49
  v_dot2c_f32_bf16 v30, v235, v53
  v_dot2c_f32_bf16 v31, v239, v53
  v_dot2c_f32_bf16 v16, v240, v50
  v_dot2c_f32_bf16 v17, v244, v50
  v_dot2c_f32_bf16 v24, v240, v54
  v_dot2c_f32_bf16 v25, v244, v54
  v_dot2c_f32_bf16 v18, v241, v50
  v_dot2c_f32_bf16 v19, v245, v50
  v_dot2c_f32_bf16 v26, v241, v54
  v_dot2c_f32_bf16 v27, v245, v54
  v_dot2c_f32_bf16 v20, v242, v50
  v_dot2c_f32_bf16 v21, v246, v50
  v_dot2c_f32_bf16 v28, v242, v54
  v_dot2c_f32_bf16 v29, v246, v54
  v_dot2c_f32_bf16 v22, v243, v50
  v_dot2c_f32_bf16 v23, v247, v50
  v_dot2c_f32_bf16 v30, v243, v54
  v_dot2c_f32_bf16 v31, v247, v54
  v_dot2c_f32_bf16 v16, v248, v51
  v_dot2c_f32_bf16 v17, v252, v51
  v_dot2c_f32_bf16 v24, v248, v55
  v_dot2c_f32_bf16 v25, v252, v55
  v_dot2c_f32_bf16 v18, v249, v51
  v_dot2c_f32_bf16 v19, v253, v51
  v_dot2c_f32_bf16 v26, v249, v55
  v_dot2c_f32_bf16 v27, v253, v55
  v_dot2c_f32_bf16 v20, v250, v51
  v_dot2c_f32_bf16 v21, v254, v51
  v_dot2c_f32_bf16 v28, v250, v55
  v_dot2c_f32_bf16 v29, v254, v55
  v_dot2c_f32_bf16 v22, v251, v51
  v_dot2c_f32_bf16 v23, v255, v51
  v_dot2c_f32_bf16 v30, v251, v55
  v_dot2c_f32_bf16 v31, v255, v55
  s_nop 2
  s_lshl_b32 s40, s33, 12
  v_lshlrev_b32 v10, 10, v2
  v_lshlrev_b32 v11, 5, v3
  v_add_u32 v10, v10, v11
  v_add_u32 v10, s40, v10
  s_nop 0
  ds_write_b128 v10, v[16:19] offset:0
  ds_write_b128 v10, v[20:23] offset:16
  ds_write_b128 v10, v[24:27] offset:512
  ds_write_b128 v10, v[28:31] offset:528
  s_waitcnt lgkmcnt(0)
  s_barrier
  v_lshlrev_b32 v10, 2, v0
  ds_read_b32 v192, v10 offset:0
  ds_read_b32 v193, v10 offset:1024
  ds_read_b32 v194, v10 offset:2048
  ds_read_b32 v195, v10 offset:3072
  ds_read_b32 v196, v10 offset:4096
  ds_read_b32 v197, v10 offset:5120
  ds_read_b32 v198, v10 offset:6144
  ds_read_b32 v199, v10 offset:7168
  ds_read_b32 v200, v10 offset:8192
  ds_read_b32 v201, v10 offset:9216
  ds_read_b32 v202, v10 offset:10240
  ds_read_b32 v203, v10 offset:11264
  ds_read_b32 v204, v10 offset:12288
  ds_read_b32 v205, v10 offset:13312
  ds_read_b32 v206, v10 offset:14336
  ds_read_b32 v207, v10 offset:15360
  s_waitcnt lgkmcnt(0)
  v_add_f32 v192, v192, v200
  v_add_f32 v193, v193, v201
  v_add_f32 v194, v194, v202
  v_add_f32 v195, v195, v203
  v_add_f32 v196, v196, v204
  v_add_f32 v197, v197, v205
  v_add_f32 v198, v198, v206
  v_add_f32 v199, v199, v207
  v_add_f32 v192, v192, v196
  v_add_f32 v193, v193, v197
  v_add_f32 v194, v194, v198
  v_add_f32 v195, v195, v199
  v_add_f32 v192, v192, v194
  v_add_f32 v193, v193, v195
  v_add_f32 v192, v192, v193
  v_cvt_pk_bf16_f32 v192, v192, v192
  v_lshlrev_b32 v10, 1, v0
  ds_write_b16 v10, v192 offset:33792
  s_waitcnt lgkmcnt(0)
  s_barrier
  s_lshl_b32 s40, s33, 4
  s_lshl_b32 s41, s56, 6
  s_add_u32 s41, s41, s40
  v_mov_b32 v10, s41
  ds_read_b128 v[192:195], v10 offset:33792
  ds_read_b128 v[196:199], v10 offset:34048
  s_lshl_b32 s41, s57, 6
  s_add_u32 s41, s41, s40
  v_mov_b32 v10, s41
  ds_read_b128 v[200:203], v10 offset:33792
  ds_read_b128 v[204:207], v10 offset:34048
  s_lshl_b32 s41, s58, 6
  s_add_u32 s41, s41, s40
  v_mov_b32 v10, s41
  ds_read_b128 v[208:211], v10 offset:33792
  ds_read_b128 v[212:215], v10 offset:34048
  s_lshl_b32 s41, s59, 6
  s_add_u32 s41, s41, s40
  v_mov_b32 v10, s41
  ds_read_b128 v[216:219], v10 offset:33792
  ds_read_b128 v[220:223], v10 offset:34048
  v_mov_b32 v16, 0
  v_mov_b32 v17, 0
  v_mov_b32 v18, 0
  v_mov_b32 v19, 0
  v_mov_b32 v20, 0
  v_mov_b32 v21, 0
  v_mov_b32 v22, 0
  v_mov_b32 v23, 0
  v_mov_b32 v24, 0
  v_mov_b32 v25, 0
  v_mov_b32 v26, 0
  v_mov_b32 v27, 0
  v_mov_b32 v28, 0
  v_mov_b32 v29, 0
  v_mov_b32 v30, 0
  v_mov_b32 v31, 0
  s_waitcnt lgkmcnt(0)
  v_dot2c_f32_bf16 v16, v64, v192
  v_dot2c_f32_bf16 v17, v68, v192
  v_dot2c_f32_bf16 v24, v64, v196
  v_dot2c_f32_bf16 v25, v68, v196
  v_dot2c_f32_bf16 v18, v65, v192
  v_dot2c_f32_bf16 v19, v69, v192
  v_dot2c_f32_bf16 v26, v65, v196
  v_dot2c_f32_bf16 v27, v69, v196
  v_dot2c_f32_bf16 v20, v66, v192
  v_dot2c_f32_bf16 v21, v70, v192
  v_dot2c_f32_bf16 v28, v66, v196
  v_dot2c_f32_bf16 v29, v70, v196
  v_dot2c_f32_bf16 v22, v67, v192
  v_dot2c_f32_bf16 v23, v71, v192
  v_dot2c_f32_bf16 v30, v67, v196
  v_dot2c_f32_bf16 v31, v71, v196
  v_dot2c_f32_bf16 v16, v72, v193
  v_dot2c_f32_bf16 v17, v76, v193
  v_dot2c_f32_bf16 v24, v72, v197
  v_dot2c_f32_bf16 v25, v76, v197
  v_dot2c_f32_bf16 v18, v73, v193
  v_dot2c_f32_bf16 v19, v77, v193
  v_dot2c_f32_bf16 v26, v73, v197
  v_dot2c_f32_bf16 v27, v77, v197
  v_dot2c_f32_bf16 v20, v74, v193
  v_dot2c_f32_bf16 v21, v78, v193
  v_dot2c_f32_bf16 v28, v74, v197
  v_dot2c_f32_bf16 v29, v78, v197
  v_dot2c_f32_bf16 v22, v75, v193
  v_dot2c_f32_bf16 v23, v79, v193
  v_dot2c_f32_bf16 v30, v75, v197
  v_dot2c_f32_bf16 v31, v79, v197
  v_dot2c_f32_bf16 v16, v80, v194
  v_dot2c_f32_bf16 v17, v84, v194
  v_dot2c_f32_bf16 v24, v80, v198
  v_dot2c_f32_bf16 v25, v84, v198
  v_dot2c_f32_bf16 v18, v81, v194
  v_dot2c_f32_bf16 v19, v85, v194
  v_dot2c_f32_bf16 v26, v81, v198
  v_dot2c_f32_bf16 v27, v85, v198
  v_dot2c_f32_bf16 v20, v82, v194
  v_dot2c_f32_bf16 v21, v86, v194
  v_dot2c_f32_bf16 v28, v82, v198
  v_dot2c_f32_bf16 v29, v86, v198
  v_dot2c_f32_bf16 v22, v83, v194
  v_dot2c_f32_bf16 v23, v87, v194
  v_dot2c_f32_bf16 v30, v83, v198
  v_dot2c_f32_bf16 v31, v87, v198
  v_dot2c_f32_bf16 v16, v88, v195
  v_dot2c_f32_bf16 v17, v92, v195
  v_dot2c_f32_bf16 v24, v88, v199
  v_dot2c_f32_bf16 v25, v92, v199
  v_dot2c_f32_bf16 v18, v89, v195
  v_dot2c_f32_bf16 v19, v93, v195
  v_dot2c_f32_bf16 v26, v89, v199
  v_dot2c_f32_bf16 v27, v93, v199
  v_dot2c_f32_bf16 v20, v90, v195
  v_dot2c_f32_bf16 v21, v94, v195
  v_dot2c_f32_bf16 v28, v90, v199
  v_dot2c_f32_bf16 v29, v94, v199
  v_dot2c_f32_bf16 v22, v91, v195
  v_dot2c_f32_bf16 v23, v95, v195
  v_dot2c_f32_bf16 v30, v91, v199
  v_dot2c_f32_bf16 v31, v95, v199
  v_dot2c_f32_bf16 v16, v96, v200
  v_dot2c_f32_bf16 v17, v100, v200
  v_dot2c_f32_bf16 v24, v96, v204
  v_dot2c_f32_bf16 v25, v100, v204
  v_dot2c_f32_bf16 v18, v97, v200
  v_dot2c_f32_bf16 v19, v101, v200
  v_dot2c_f32_bf16 v26, v97, v204
  v_dot2c_f32_bf16 v27, v101, v204
  v_dot2c_f32_bf16 v20, v98, v200
  v_dot2c_f32_bf16 v21, v102, v200
  v_dot2c_f32_bf16 v28, v98, v204
  v_dot2c_f32_bf16 v29, v102, v204
  v_dot2c_f32_bf16 v22, v99, v200
  v_dot2c_f32_bf16 v23, v103, v200
  v_dot2c_f32_bf16 v30, v99, v204
  v_dot2c_f32_bf16 v31, v103, v204
  v_dot2c_f32_bf16 v16, v104, v201
  v_dot2c_f32_bf16 v17, v108, v201
  v_dot2c_f32_bf16 v24, v104, v205
  v_dot2c_f32_bf16 v25, v108, v205
  v_dot2c_f32_bf16 v18, v105, v201
  v_dot2c_f32_bf16 v19, v109, v201
  v_dot2c_f32_bf16 v26, v105, v205
  v_dot2c_f32_bf16 v27, v109, v205
  v_dot2c_f32_bf16 v20, v106, v201
  v_dot2c_f32_bf16 v21, v110, v201
  v_dot2c_f32_bf16 v28, v106, v205
  v_dot2c_f32_bf16 v29, v110, v205
  v_dot2c_f32_bf16 v22, v107, v201
  v_dot2c_f32_bf16 v23, v111, v201
  v_dot2c_f32_bf16 v30, v107, v205
  v_dot2c_f32_bf16 v31, v111, v205
  v_dot2c_f32_bf16 v16, v112, v202
  v_dot2c_f32_bf16 v17, v116, v202
  v_dot2c_f32_bf16 v24, v112, v206
  v_dot2c_f32_bf16 v25, v116, v206
  v_dot2c_f32_bf16 v18, v113, v202
  v_dot2c_f32_bf16 v19, v117, v202
  v_dot2c_f32_bf16 v26, v113, v206
  v_dot2c_f32_bf16 v27, v117, v206
  v_dot2c_f32_bf16 v20, v114, v202
  v_dot2c_f32_bf16 v21, v118, v202
  v_dot2c_f32_bf16 v28, v114, v206
  v_dot2c_f32_bf16 v29, v118, v206
  v_dot2c_f32_bf16 v22, v115, v202
  v_dot2c_f32_bf16 v23, v119, v202
  v_dot2c_f32_bf16 v30, v115, v206
  v_dot2c_f32_bf16 v31, v119, v206
  v_dot2c_f32_bf16 v16, v120, v203
  v_dot2c_f32_bf16 v17, v124, v203
  v_dot2c_f32_bf16 v24, v120, v207
  v_dot2c_f32_bf16 v25, v124, v207
  v_dot2c_f32_bf16 v18, v121, v203
  v_dot2c_f32_bf16 v19, v125, v203
  v_dot2c_f32_bf16 v26, v121, v207
  v_dot2c_f32_bf16 v27, v125, v207
  v_dot2c_f32_bf16 v20, v122, v203
  v_dot2c_f32_bf16 v21, v126, v203
  v_dot2c_f32_bf16 v28, v122, v207
  v_dot2c_f32_bf16 v29, v126, v207
  v_dot2c_f32_bf16 v22, v123, v203
  v_dot2c_f32_bf16 v23, v127, v203
  v_dot2c_f32_bf16 v30, v123, v207
  v_dot2c_f32_bf16 v31, v127, v207
  v_dot2c_f32_bf16 v16, v128, v208
  v_dot2c_f32_bf16 v17, v132, v208
  v_dot2c_f32_bf16 v24, v128, v212
  v_dot2c_f32_bf16 v25, v132, v212
  v_dot2c_f32_bf16 v18, v129, v208
  v_dot2c_f32_bf16 v19, v133, v208
  v_dot2c_f32_bf16 v26, v129, v212
  v_dot2c_f32_bf16 v27, v133, v212
  v_dot2c_f32_bf16 v20, v130, v208
  v_dot2c_f32_bf16 v21, v134, v208
  v_dot2c_f32_bf16 v28, v130, v212
  v_dot2c_f32_bf16 v29, v134, v212
  v_dot2c_f32_bf16 v22, v131, v208
  v_dot2c_f32_bf16 v23, v135, v208
  v_dot2c_f32_bf16 v30, v131, v212
  v_dot2c_f32_bf16 v31, v135, v212
  v_dot2c_f32_bf16 v16, v136, v209
  v_dot2c_f32_bf16 v17, v140, v209
  v_dot2c_f32_bf16 v24, v136, v213
  v_dot2c_f32_bf16 v25, v140, v213
  v_dot2c_f32_bf16 v18, v137, v209
  v_dot2c_f32_bf16 v19, v141, v209
  v_dot2c_f32_bf16 v26, v137, v213
  v_dot2c_f32_bf16 v27, v141, v213
  v_dot2c_f32_bf16 v20, v138, v209
  v_dot2c_f32_bf16 v21, v142, v209
  v_dot2c_f32_bf16 v28, v138, v213
  v_dot2c_f32_bf16 v29, v142, v213
  v_dot2c_f32_bf16 v22, v139, v209
  v_dot2c_f32_bf16 v23, v143, v209
  v_dot2c_f32_bf16 v30, v139, v213
  v_dot2c_f32_bf16 v31, v143, v213
  v_dot2c_f32_bf16 v16, v144, v210
  v_dot2c_f32_bf16 v17, v148, v210
  v_dot2c_f32_bf16 v24, v144, v214
  v_dot2c_f32_bf16 v25, v148, v214
  v_dot2c_f32_bf16 v18, v145, v210
  v_dot2c_f32_bf16 v19, v149, v210
  v_dot2c_f32_bf16 v26, v145, v214
  v_dot2c_f32_bf16 v27, v149, v214
  v_dot2c_f32_bf16 v20, v146, v210
  v_dot2c_f32_bf16 v21, v150, v210
  v_dot2c_f32_bf16 v28, v146, v214
  v_dot2c_f32_bf16 v29, v150, v214
  v_dot2c_f32_bf16 v22, v147, v210
  v_dot2c_f32_bf16 v23, v151, v210
  v_dot2c_f32_bf16 v30, v147, v214
  v_dot2c_f32_bf16 v31, v151, v214
  v_dot2c_f32_bf16 v16, v152, v211
  v_dot2c_f32_bf16 v17, v156, v211
  v_dot2c_f32_bf16 v24, v152, v215
  v_dot2c_f32_bf16 v25, v156, v215
  v_dot2c_f32_bf16 v18, v153, v211
  v_dot2c_f32_bf16 v19, v157, v211
  v_dot2c_f32_bf16 v26, v153, v215
  v_dot2c_f32_bf16 v27, v157, v215
  v_dot2c_f32_bf16 v20, v154, v211
  v_dot2c_f32_bf16 v21, v158, v211
  v_dot2c_f32_bf16 v28, v154, v215
  v_dot2c_f32_bf16 v29, v158, v215
  v_dot2c_f32_bf16 v22, v155, v211
  v_dot2c_f32_bf16 v23, v159, v211
  v_dot2c_f32_bf16 v30, v155, v215
  v_dot2c_f32_bf16 v31, v159, v215
  v_dot2c_f32_bf16 v16, v160, v216
  v_dot2c_f32_bf16 v17, v164, v216
  v_dot2c_f32_bf16 v24, v160, v220
  v_dot2c_f32_bf16 v25, v164, v220
  v_dot2c_f32_bf16 v18, v161, v216
  v_dot2c_f32_bf16 v19, v165, v216
  v_dot2c_f32_bf16 v26, v161, v220
  v_dot2c_f32_bf16 v27, v165, v220
  v_dot2c_f32_bf16 v20, v162, v216
  v_dot2c_f32_bf16 v21, v166, v216
  v_dot2c_f32_bf16 v28, v162, v220
  v_dot2c_f32_bf16 v29, v166, v220
  v_dot2c_f32_bf16 v22, v163, v216
  v_dot2c_f32_bf16 v23, v167, v216
  v_dot2c_f32_bf16 v30, v163, v220
  v_dot2c_f32_bf16 v31, v167, v220
  v_dot2c_f32_bf16 v16, v168, v217
  v_dot2c_f32_bf16 v17, v172, v217
  v_dot2c_f32_bf16 v24, v168, v221
  v_dot2c_f32_bf16 v25, v172, v221
  v_dot2c_f32_bf16 v18, v169, v217
  v_dot2c_f32_bf16 v19, v173, v217
  v_dot2c_f32_bf16 v26, v169, v221
  v_dot2c_f32_bf16 v27, v173, v221
  v_dot2c_f32_bf16 v20, v170, v217
  v_dot2c_f32_bf16 v21, v174, v217
  v_dot2c_f32_bf16 v28, v170, v221
  v_dot2c_f32_bf16 v29, v174, v221
  v_dot2c_f32_bf16 v22, v171, v217
  v_dot2c_f32_bf16 v23, v175, v217
  v_dot2c_f32_bf16 v30, v171, v221
  v_dot2c_f32_bf16 v31, v175, v221
  v_dot2c_f32_bf16 v16, v176, v218
  v_dot2c_f32_bf16 v17, v180, v218
  v_dot2c_f32_bf16 v24, v176, v222
  v_dot2c_f32_bf16 v25, v180, v222
  v_dot2c_f32_bf16 v18, v177, v218
  v_dot2c_f32_bf16 v19, v181, v218
  v_dot2c_f32_bf16 v26, v177, v222
  v_dot2c_f32_bf16 v27, v181, v222
  v_dot2c_f32_bf16 v20, v178, v218
  v_dot2c_f32_bf16 v21, v182, v218
  v_dot2c_f32_bf16 v28, v178, v222
  v_dot2c_f32_bf16 v29, v182, v222
  v_dot2c_f32_bf16 v22, v179, v218
  v_dot2c_f32_bf16 v23, v183, v218
  v_dot2c_f32_bf16 v30, v179, v222
  v_dot2c_f32_bf16 v31, v183, v222
  v_dot2c_f32_bf16 v16, v184, v219
  v_dot2c_f32_bf16 v17, v188, v219
  v_dot2c_f32_bf16 v24, v184, v223
  v_dot2c_f32_bf16 v25, v188, v223
  v_dot2c_f32_bf16 v18, v185, v219
  v_dot2c_f32_bf16 v19, v189, v219
  v_dot2c_f32_bf16 v26, v185, v223
  v_dot2c_f32_bf16 v27, v189, v223
  v_dot2c_f32_bf16 v20, v186, v219
  v_dot2c_f32_bf16 v21, v190, v219
  v_dot2c_f32_bf16 v28, v186, v223
  v_dot2c_f32_bf16 v29, v190, v223
  v_dot2c_f32_bf16 v22, v187, v219
  v_dot2c_f32_bf16 v23, v191, v219
  v_dot2c_f32_bf16 v30, v187, v223
  v_dot2c_f32_bf16 v31, v191, v223
  s_nop 2
  s_lshl_b32 s40, s33, 12
  v_lshlrev_b32 v10, 5, v1
  v_add_u32 v10, s40, v10
  s_nop 1
  ds_write_b128 v10, v[16:19] offset:0
  ds_write_b128 v10, v[20:23] offset:16
  ds_write_b128 v10, v[24:27] offset:2048
  ds_write_b128 v10, v[28:31] offset:2064
  s_waitcnt lgkmcnt(0)
  s_barrier
  v_lshlrev_b32 v10, 4, v0
  ds_read_b128 v[16:19], v10 offset:0
  ds_read_b128 v[20:23], v10 offset:4096
  ds_read_b128 v[24:27], v10 offset:8192
  ds_read_b128 v[28:31], v10 offset:12288
  s_waitcnt lgkmcnt(0)
  v_add_f32 v16, v16, v20
  v_add_f32 v24, v24, v28
  v_add_f32 v17, v17, v21
  v_add_f32 v25, v25, v29
  v_add_f32 v18, v18, v22
  v_add_f32 v26, v26, v30
  v_add_f32 v19, v19, v23
  v_add_f32 v27, v27, v31
  v_add_f32 v16, v16, v24
  v_min_u32 v16, -2, v16
  v_add_f32 v17, v17, v25
  v_min_u32 v17, -2, v17
  v_add_f32 v18, v18, v26
  v_min_u32 v18, -2, v18
  v_add_f32 v19, v19, v27
  v_min_u32 v19, -2, v19
  s_lshl_b32 s40, s52, 12
  s_add_u32 s40, s40, 262144
  v_add_u32 v10, s40, v10
  global_store_dwordx4 v10, v[16:19], s[30:31] sc1
  s_endpgm
role_b2:
  s_and_b32 s34, s52, 31
  s_lshr_b32 s35, s52, 5
  v_lshrrev_b32 v2, 4, v1
  v_and_b32 v3, 15, v1
  s_add_u32 s56, s35, 0
  s_and_b32 s56, s56, 3
  s_add_u32 s57, s35, 1
  s_and_b32 s57, s57, 3
  s_add_u32 s58, s35, 2
  s_and_b32 s58, s58, 3
  s_add_u32 s59, s35, 3
  s_and_b32 s59, s59, 3
  s_lshl_b32 s40, s33, 6
  v_lshlrev_b32 v12, 4, v2
  v_add_u32 v12, s40, v12
  s_lshl_b32 s40, s33, 18
  s_lshl_b32 s41, s34, 8
  s_add_u32 s40, s40, s41
  v_lshlrev_b32 v13, 16, v2
  v_lshlrev_b32 v11, 4, v3
  v_add_u32 v13, v13, v11
  v_add_u32 v13, s40, v13
  s_lshl_b32 s42, s56, 8
  v_add_u32 v10, s42, v12
  global_load_dwordx4 v[32:35], v10, s[4:5] offset:0
  global_load_dwordx4 v[36:39], v10, s[4:5] offset:1024
  s_lshl_b32 s42, s57, 8
  v_add_u32 v10, s42, v12
  global_load_dwordx4 v[40:43], v10, s[4:5] offset:0
  global_load_dwordx4 v[44:47], v10, s[4:5] offset:1024
  s_lshl_b32 s42, s58, 8
  v_add_u32 v10, s42, v12
  global_load_dwordx4 v[48:51], v10, s[4:5] offset:0
  global_load_dwordx4 v[52:55], v10, s[4:5] offset:1024
  s_lshl_b32 s42, s59, 8
  v_add_u32 v10, s42, v12
  global_load_dwordx4 v[56:59], v10, s[4:5] offset:0
  global_load_dwordx4 v[60:63], v10, s[4:5] offset:1024
  s_lshl_b32 s42, s56, 20
  v_add_u32 v10, s42, v13
  global_load_dwordx4 v[64:67], v10, s[8:9]
  v_add_u32 v10, 0x2000, v10
  global_load_dwordx4 v[68:71], v10, s[8:9]
  v_add_u32 v10, 0x2000, v10
  global_load_dwordx4 v[72:75], v10, s[8:9]
  v_add_u32 v10, 0x2000, v10
  global_load_dwordx4 v[76:79], v10, s[8:9]
  v_add_u32 v10, 0x2000, v10
  global_load_dwordx4 v[80:83], v10, s[8:9]
  v_add_u32 v10, 0x2000, v10
  global_load_dwordx4 v[84:87], v10, s[8:9]
  v_add_u32 v10, 0x2000, v10
  global_load_dwordx4 v[88:91], v10, s[8:9]
  v_add_u32 v10, 0x2000, v10
  global_load_dwordx4 v[92:95], v10, s[8:9]
  s_lshl_b32 s40, s35, 20
  s_lshl_b32 s42, s33, 18
  s_add_u32 s40, s40, s42
  s_add_u32 s40, s40, s41
  v_lshlrev_b32 v10, 13, v3
  v_lshlrev_b32 v11, 4, v2
  v_add_u32 v10, v10, v11
  v_add_u32 v10, s40, v10
  global_load_dwordx4 v[192:195], v10, s[10:11] offset:0
  global_load_dwordx4 v[196:199], v10, s[10:11] offset:64
  global_load_dwordx4 v[200:203], v10, s[10:11] offset:128
  global_load_dwordx4 v[204:207], v10, s[10:11] offset:192
  v_add_u32 v10, 0x20000, v10
  global_load_dwordx4 v[208:211], v10, s[10:11] offset:0
  global_load_dwordx4 v[212:215], v10, s[10:11] offset:64
  global_load_dwordx4 v[216:219], v10, s[10:11] offset:128
  global_load_dwordx4 v[220:223], v10, s[10:11] offset:192
  s_waitcnt vmcnt(8)
  s_lshl_b32 s42, s57, 20
  v_add_u32 v10, s42, v13
  global_load_dwordx4 v[96:99], v10, s[8:9]
  v_add_u32 v10, 0x2000, v10
  global_load_dwordx4 v[100:103], v10, s[8:9]
  v_add_u32 v10, 0x2000, v10
  global_load_dwordx4 v[104:107], v10, s[8:9]
  v_add_u32 v10, 0x2000, v10
  global_load_dwordx4 v[108:111], v10, s[8:9]
  v_add_u32 v10, 0x2000, v10
  global_load_dwordx4 v[112:115], v10, s[8:9]
  v_add_u32 v10, 0x2000, v10
  global_load_dwordx4 v[116:119], v10, s[8:9]
  v_add_u32 v10, 0x2000, v10
  global_load_dwordx4 v[120:123], v10, s[8:9]
  v_add_u32 v10, 0x2000, v10
  global_load_dwordx4 v[124:127], v10, s[8:9]
  s_lshl_b32 s42, s58, 20
  v_add_u32 v10, s42, v13
  global_load_dwordx4 v[128:131], v10, s[8:9]
  v_add_u32 v10, 0x2000, v10
  global_load_dwordx4 v[132:135], v10, s[8:9]
  v_add_u32 v10, 0x2000, v10
  global_load_dwordx4 v[136:139], v10, s[8:9]
  v_add_u32 v10, 0x2000, v10
  global_load_dwordx4 v[140:143], v10, s[8:9]
  v_add_u32 v10, 0x2000, v10
  global_load_dwordx4 v[144:147], v10, s[8:9]
  v_add_u32 v10, 0x2000, v10
  global_load_dwordx4 v[148:151], v10, s[8:9]
  v_add_u32 v10, 0x2000, v10
  global_load_dwordx4 v[152:155], v10, s[8:9]
  v_add_u32 v10, 0x2000, v10
  global_load_dwordx4 v[156:159], v10, s[8:9]
  s_lshl_b32 s42, s59, 20
  v_add_u32 v10, s42, v13
  global_load_dwordx4 v[160:163], v10, s[8:9]
  v_add_u32 v10, 0x2000, v10
  global_load_dwordx4 v[164:167], v10, s[8:9]
  v_add_u32 v10, 0x2000, v10
  global_load_dwordx4 v[168:171], v10, s[8:9]
  v_add_u32 v10, 0x2000, v10
  global_load_dwordx4 v[172:175], v10, s[8:9]
  v_add_u32 v10, 0x2000, v10
  global_load_dwordx4 v[176:179], v10, s[8:9]
  v_add_u32 v10, 0x2000, v10
  global_load_dwordx4 v[180:183], v10, s[8:9]
  v_add_u32 v10, 0x2000, v10
  global_load_dwordx4 v[184:187], v10, s[8:9]
  v_add_u32 v10, 0x2000, v10
  global_load_dwordx4 v[188:191], v10, s[8:9]
  v_mov_b32 v16, 0
  v_mov_b32 v17, 0
  v_mov_b32 v18, 0
  v_mov_b32 v19, 0
  v_mov_b32 v20, 0
  v_mov_b32 v21, 0
  v_mov_b32 v22, 0
  v_mov_b32 v23, 0
  v_mov_b32 v24, 0
  v_mov_b32 v25, 0
  v_mov_b32 v26, 0
  v_mov_b32 v27, 0
  v_mov_b32 v28, 0
  v_mov_b32 v29, 0
  v_mov_b32 v30, 0
  v_mov_b32 v31, 0
  v_perm_b32 v4, v68, v64, s36
  v_perm_b32 v5, v68, v64, s37
  v_dot2c_f32_bf16 v16, v4, v32
  v_dot2c_f32_bf16 v17, v5, v32
  v_dot2c_f32_bf16 v24, v4, v36
  v_dot2c_f32_bf16 v25, v5, v36
  v_perm_b32 v4, v69, v65, s36
  v_perm_b32 v5, v69, v65, s37
  v_dot2c_f32_bf16 v18, v4, v32
  v_dot2c_f32_bf16 v19, v5, v32
  v_dot2c_f32_bf16 v26, v4, v36
  v_dot2c_f32_bf16 v27, v5, v36
  v_perm_b32 v4, v70, v66, s36
  v_perm_b32 v5, v70, v66, s37
  v_dot2c_f32_bf16 v20, v4, v32
  v_dot2c_f32_bf16 v21, v5, v32
  v_dot2c_f32_bf16 v28, v4, v36
  v_dot2c_f32_bf16 v29, v5, v36
  v_perm_b32 v4, v71, v67, s36
  v_perm_b32 v5, v71, v67, s37
  v_dot2c_f32_bf16 v22, v4, v32
  v_dot2c_f32_bf16 v23, v5, v32
  v_dot2c_f32_bf16 v30, v4, v36
  v_dot2c_f32_bf16 v31, v5, v36
  v_perm_b32 v4, v76, v72, s36
  v_perm_b32 v5, v76, v72, s37
  v_dot2c_f32_bf16 v16, v4, v33
  v_dot2c_f32_bf16 v17, v5, v33
  v_dot2c_f32_bf16 v24, v4, v37
  v_dot2c_f32_bf16 v25, v5, v37
  v_perm_b32 v4, v77, v73, s36
  v_perm_b32 v5, v77, v73, s37
  v_dot2c_f32_bf16 v18, v4, v33
  v_dot2c_f32_bf16 v19, v5, v33
  v_dot2c_f32_bf16 v26, v4, v37
  v_dot2c_f32_bf16 v27, v5, v37
  v_perm_b32 v4, v78, v74, s36
  v_perm_b32 v5, v78, v74, s37
  v_dot2c_f32_bf16 v20, v4, v33
  v_dot2c_f32_bf16 v21, v5, v33
  v_dot2c_f32_bf16 v28, v4, v37
  v_dot2c_f32_bf16 v29, v5, v37
  v_perm_b32 v4, v79, v75, s36
  v_perm_b32 v5, v79, v75, s37
  v_dot2c_f32_bf16 v22, v4, v33
  v_dot2c_f32_bf16 v23, v5, v33
  v_dot2c_f32_bf16 v30, v4, v37
  v_dot2c_f32_bf16 v31, v5, v37
  v_perm_b32 v4, v84, v80, s36
  v_perm_b32 v5, v84, v80, s37
  v_dot2c_f32_bf16 v16, v4, v34
  v_dot2c_f32_bf16 v17, v5, v34
  v_dot2c_f32_bf16 v24, v4, v38
  v_dot2c_f32_bf16 v25, v5, v38
  v_perm_b32 v4, v85, v81, s36
  v_perm_b32 v5, v85, v81, s37
  v_dot2c_f32_bf16 v18, v4, v34
  v_dot2c_f32_bf16 v19, v5, v34
  v_dot2c_f32_bf16 v26, v4, v38
  v_dot2c_f32_bf16 v27, v5, v38
  v_perm_b32 v4, v86, v82, s36
  v_perm_b32 v5, v86, v82, s37
  v_dot2c_f32_bf16 v20, v4, v34
  v_dot2c_f32_bf16 v21, v5, v34
  v_dot2c_f32_bf16 v28, v4, v38
  v_dot2c_f32_bf16 v29, v5, v38
  v_perm_b32 v4, v87, v83, s36
  v_perm_b32 v5, v87, v83, s37
  v_dot2c_f32_bf16 v22, v4, v34
  v_dot2c_f32_bf16 v23, v5, v34
  v_dot2c_f32_bf16 v30, v4, v38
  v_dot2c_f32_bf16 v31, v5, v38
  v_perm_b32 v4, v92, v88, s36
  v_perm_b32 v5, v92, v88, s37
  v_dot2c_f32_bf16 v16, v4, v35
  v_dot2c_f32_bf16 v17, v5, v35
  v_dot2c_f32_bf16 v24, v4, v39
  v_dot2c_f32_bf16 v25, v5, v39
  v_perm_b32 v4, v93, v89, s36
  v_perm_b32 v5, v93, v89, s37
  v_dot2c_f32_bf16 v18, v4, v35
  v_dot2c_f32_bf16 v19, v5, v35
  v_dot2c_f32_bf16 v26, v4, v39
  v_dot2c_f32_bf16 v27, v5, v39
  v_perm_b32 v4, v94, v90, s36
  v_perm_b32 v5, v94, v90, s37
  v_dot2c_f32_bf16 v20, v4, v35
  v_dot2c_f32_bf16 v21, v5, v35
  v_dot2c_f32_bf16 v28, v4, v39
  v_dot2c_f32_bf16 v29, v5, v39
  v_perm_b32 v4, v95, v91, s36
  v_perm_b32 v5, v95, v91, s37
  v_dot2c_f32_bf16 v22, v4, v35
  v_dot2c_f32_bf16 v23, v5, v35
  v_dot2c_f32_bf16 v30, v4, v39
  v_dot2c_f32_bf16 v31, v5, v39
  s_waitcnt vmcnt(16)
  v_perm_b32 v4, v100, v96, s36
  v_perm_b32 v5, v100, v96, s37
  v_dot2c_f32_bf16 v16, v4, v40
  v_dot2c_f32_bf16 v17, v5, v40
  v_dot2c_f32_bf16 v24, v4, v44
  v_dot2c_f32_bf16 v25, v5, v44
  v_perm_b32 v4, v101, v97, s36
  v_perm_b32 v5, v101, v97, s37
  v_dot2c_f32_bf16 v18, v4, v40
  v_dot2c_f32_bf16 v19, v5, v40
  v_dot2c_f32_bf16 v26, v4, v44
  v_dot2c_f32_bf16 v27, v5, v44
  v_perm_b32 v4, v102, v98, s36
  v_perm_b32 v5, v102, v98, s37
  v_dot2c_f32_bf16 v20, v4, v40
  v_dot2c_f32_bf16 v21, v5, v40
  v_dot2c_f32_bf16 v28, v4, v44
  v_dot2c_f32_bf16 v29, v5, v44
  v_perm_b32 v4, v103, v99, s36
  v_perm_b32 v5, v103, v99, s37
  v_dot2c_f32_bf16 v22, v4, v40
  v_dot2c_f32_bf16 v23, v5, v40
  v_dot2c_f32_bf16 v30, v4, v44
  v_dot2c_f32_bf16 v31, v5, v44
  v_perm_b32 v4, v108, v104, s36
  v_perm_b32 v5, v108, v104, s37
  v_dot2c_f32_bf16 v16, v4, v41
  v_dot2c_f32_bf16 v17, v5, v41
  v_dot2c_f32_bf16 v24, v4, v45
  v_dot2c_f32_bf16 v25, v5, v45
  v_perm_b32 v4, v109, v105, s36
  v_perm_b32 v5, v109, v105, s37
  v_dot2c_f32_bf16 v18, v4, v41
  v_dot2c_f32_bf16 v19, v5, v41
  v_dot2c_f32_bf16 v26, v4, v45
  v_dot2c_f32_bf16 v27, v5, v45
  v_perm_b32 v4, v110, v106, s36
  v_perm_b32 v5, v110, v106, s37
  v_dot2c_f32_bf16 v20, v4, v41
  v_dot2c_f32_bf16 v21, v5, v41
  v_dot2c_f32_bf16 v28, v4, v45
  v_dot2c_f32_bf16 v29, v5, v45
  v_perm_b32 v4, v111, v107, s36
  v_perm_b32 v5, v111, v107, s37
  v_dot2c_f32_bf16 v22, v4, v41
  v_dot2c_f32_bf16 v23, v5, v41
  v_dot2c_f32_bf16 v30, v4, v45
  v_dot2c_f32_bf16 v31, v5, v45
  v_perm_b32 v4, v116, v112, s36
  v_perm_b32 v5, v116, v112, s37
  v_dot2c_f32_bf16 v16, v4, v42
  v_dot2c_f32_bf16 v17, v5, v42
  v_dot2c_f32_bf16 v24, v4, v46
  v_dot2c_f32_bf16 v25, v5, v46
  v_perm_b32 v4, v117, v113, s36
  v_perm_b32 v5, v117, v113, s37
  v_dot2c_f32_bf16 v18, v4, v42
  v_dot2c_f32_bf16 v19, v5, v42
  v_dot2c_f32_bf16 v26, v4, v46
  v_dot2c_f32_bf16 v27, v5, v46
  v_perm_b32 v4, v118, v114, s36
  v_perm_b32 v5, v118, v114, s37
  v_dot2c_f32_bf16 v20, v4, v42
  v_dot2c_f32_bf16 v21, v5, v42
  v_dot2c_f32_bf16 v28, v4, v46
  v_dot2c_f32_bf16 v29, v5, v46
  v_perm_b32 v4, v119, v115, s36
  v_perm_b32 v5, v119, v115, s37
  v_dot2c_f32_bf16 v22, v4, v42
  v_dot2c_f32_bf16 v23, v5, v42
  v_dot2c_f32_bf16 v30, v4, v46
  v_dot2c_f32_bf16 v31, v5, v46
  v_perm_b32 v4, v124, v120, s36
  v_perm_b32 v5, v124, v120, s37
  v_dot2c_f32_bf16 v16, v4, v43
  v_dot2c_f32_bf16 v17, v5, v43
  v_dot2c_f32_bf16 v24, v4, v47
  v_dot2c_f32_bf16 v25, v5, v47
  v_perm_b32 v4, v125, v121, s36
  v_perm_b32 v5, v125, v121, s37
  v_dot2c_f32_bf16 v18, v4, v43
  v_dot2c_f32_bf16 v19, v5, v43
  v_dot2c_f32_bf16 v26, v4, v47
  v_dot2c_f32_bf16 v27, v5, v47
  v_perm_b32 v4, v126, v122, s36
  v_perm_b32 v5, v126, v122, s37
  v_dot2c_f32_bf16 v20, v4, v43
  v_dot2c_f32_bf16 v21, v5, v43
  v_dot2c_f32_bf16 v28, v4, v47
  v_dot2c_f32_bf16 v29, v5, v47
  v_perm_b32 v4, v127, v123, s36
  v_perm_b32 v5, v127, v123, s37
  v_dot2c_f32_bf16 v22, v4, v43
  v_dot2c_f32_bf16 v23, v5, v43
  v_dot2c_f32_bf16 v30, v4, v47
  v_dot2c_f32_bf16 v31, v5, v47
  s_waitcnt vmcnt(8)
  v_perm_b32 v4, v132, v128, s36
  v_perm_b32 v5, v132, v128, s37
  v_dot2c_f32_bf16 v16, v4, v48
  v_dot2c_f32_bf16 v17, v5, v48
  v_dot2c_f32_bf16 v24, v4, v52
  v_dot2c_f32_bf16 v25, v5, v52
  v_perm_b32 v4, v133, v129, s36
  v_perm_b32 v5, v133, v129, s37
  v_dot2c_f32_bf16 v18, v4, v48
  v_dot2c_f32_bf16 v19, v5, v48
  v_dot2c_f32_bf16 v26, v4, v52
  v_dot2c_f32_bf16 v27, v5, v52
  v_perm_b32 v4, v134, v130, s36
  v_perm_b32 v5, v134, v130, s37
  v_dot2c_f32_bf16 v20, v4, v48
  v_dot2c_f32_bf16 v21, v5, v48
  v_dot2c_f32_bf16 v28, v4, v52
  v_dot2c_f32_bf16 v29, v5, v52
  v_perm_b32 v4, v135, v131, s36
  v_perm_b32 v5, v135, v131, s37
  v_dot2c_f32_bf16 v22, v4, v48
  v_dot2c_f32_bf16 v23, v5, v48
  v_dot2c_f32_bf16 v30, v4, v52
  v_dot2c_f32_bf16 v31, v5, v52
  v_perm_b32 v4, v140, v136, s36
  v_perm_b32 v5, v140, v136, s37
  v_dot2c_f32_bf16 v16, v4, v49
  v_dot2c_f32_bf16 v17, v5, v49
  v_dot2c_f32_bf16 v24, v4, v53
  v_dot2c_f32_bf16 v25, v5, v53
  v_perm_b32 v4, v141, v137, s36
  v_perm_b32 v5, v141, v137, s37
  v_dot2c_f32_bf16 v18, v4, v49
  v_dot2c_f32_bf16 v19, v5, v49
  v_dot2c_f32_bf16 v26, v4, v53
  v_dot2c_f32_bf16 v27, v5, v53
  v_perm_b32 v4, v142, v138, s36
  v_perm_b32 v5, v142, v138, s37
  v_dot2c_f32_bf16 v20, v4, v49
  v_dot2c_f32_bf16 v21, v5, v49
  v_dot2c_f32_bf16 v28, v4, v53
  v_dot2c_f32_bf16 v29, v5, v53
  v_perm_b32 v4, v143, v139, s36
  v_perm_b32 v5, v143, v139, s37
  v_dot2c_f32_bf16 v22, v4, v49
  v_dot2c_f32_bf16 v23, v5, v49
  v_dot2c_f32_bf16 v30, v4, v53
  v_dot2c_f32_bf16 v31, v5, v53
  v_perm_b32 v4, v148, v144, s36
  v_perm_b32 v5, v148, v144, s37
  v_dot2c_f32_bf16 v16, v4, v50
  v_dot2c_f32_bf16 v17, v5, v50
  v_dot2c_f32_bf16 v24, v4, v54
  v_dot2c_f32_bf16 v25, v5, v54
  v_perm_b32 v4, v149, v145, s36
  v_perm_b32 v5, v149, v145, s37
  v_dot2c_f32_bf16 v18, v4, v50
  v_dot2c_f32_bf16 v19, v5, v50
  v_dot2c_f32_bf16 v26, v4, v54
  v_dot2c_f32_bf16 v27, v5, v54
  v_perm_b32 v4, v150, v146, s36
  v_perm_b32 v5, v150, v146, s37
  v_dot2c_f32_bf16 v20, v4, v50
  v_dot2c_f32_bf16 v21, v5, v50
  v_dot2c_f32_bf16 v28, v4, v54
  v_dot2c_f32_bf16 v29, v5, v54
  v_perm_b32 v4, v151, v147, s36
  v_perm_b32 v5, v151, v147, s37
  v_dot2c_f32_bf16 v22, v4, v50
  v_dot2c_f32_bf16 v23, v5, v50
  v_dot2c_f32_bf16 v30, v4, v54
  v_dot2c_f32_bf16 v31, v5, v54
  v_perm_b32 v4, v156, v152, s36
  v_perm_b32 v5, v156, v152, s37
  v_dot2c_f32_bf16 v16, v4, v51
  v_dot2c_f32_bf16 v17, v5, v51
  v_dot2c_f32_bf16 v24, v4, v55
  v_dot2c_f32_bf16 v25, v5, v55
  v_perm_b32 v4, v157, v153, s36
  v_perm_b32 v5, v157, v153, s37
  v_dot2c_f32_bf16 v18, v4, v51
  v_dot2c_f32_bf16 v19, v5, v51
  v_dot2c_f32_bf16 v26, v4, v55
  v_dot2c_f32_bf16 v27, v5, v55
  v_perm_b32 v4, v158, v154, s36
  v_perm_b32 v5, v158, v154, s37
  v_dot2c_f32_bf16 v20, v4, v51
  v_dot2c_f32_bf16 v21, v5, v51
  v_dot2c_f32_bf16 v28, v4, v55
  v_dot2c_f32_bf16 v29, v5, v55
  v_perm_b32 v4, v159, v155, s36
  v_perm_b32 v5, v159, v155, s37
  v_dot2c_f32_bf16 v22, v4, v51
  v_dot2c_f32_bf16 v23, v5, v51
  v_dot2c_f32_bf16 v30, v4, v55
  v_dot2c_f32_bf16 v31, v5, v55
  s_waitcnt vmcnt(0)
  v_perm_b32 v4, v164, v160, s36
  v_perm_b32 v5, v164, v160, s37
  v_dot2c_f32_bf16 v16, v4, v56
  v_dot2c_f32_bf16 v17, v5, v56
  v_dot2c_f32_bf16 v24, v4, v60
  v_dot2c_f32_bf16 v25, v5, v60
  v_perm_b32 v4, v165, v161, s36
  v_perm_b32 v5, v165, v161, s37
  v_dot2c_f32_bf16 v18, v4, v56
  v_dot2c_f32_bf16 v19, v5, v56
  v_dot2c_f32_bf16 v26, v4, v60
  v_dot2c_f32_bf16 v27, v5, v60
  v_perm_b32 v4, v166, v162, s36
  v_perm_b32 v5, v166, v162, s37
  v_dot2c_f32_bf16 v20, v4, v56
  v_dot2c_f32_bf16 v21, v5, v56
  v_dot2c_f32_bf16 v28, v4, v60
  v_dot2c_f32_bf16 v29, v5, v60
  v_perm_b32 v4, v167, v163, s36
  v_perm_b32 v5, v167, v163, s37
  v_dot2c_f32_bf16 v22, v4, v56
  v_dot2c_f32_bf16 v23, v5, v56
  v_dot2c_f32_bf16 v30, v4, v60
  v_dot2c_f32_bf16 v31, v5, v60
  v_perm_b32 v4, v172, v168, s36
  v_perm_b32 v5, v172, v168, s37
  v_dot2c_f32_bf16 v16, v4, v57
  v_dot2c_f32_bf16 v17, v5, v57
  v_dot2c_f32_bf16 v24, v4, v61
  v_dot2c_f32_bf16 v25, v5, v61
  v_perm_b32 v4, v173, v169, s36
  v_perm_b32 v5, v173, v169, s37
  v_dot2c_f32_bf16 v18, v4, v57
  v_dot2c_f32_bf16 v19, v5, v57
  v_dot2c_f32_bf16 v26, v4, v61
  v_dot2c_f32_bf16 v27, v5, v61
  v_perm_b32 v4, v174, v170, s36
  v_perm_b32 v5, v174, v170, s37
  v_dot2c_f32_bf16 v20, v4, v57
  v_dot2c_f32_bf16 v21, v5, v57
  v_dot2c_f32_bf16 v28, v4, v61
  v_dot2c_f32_bf16 v29, v5, v61
  v_perm_b32 v4, v175, v171, s36
  v_perm_b32 v5, v175, v171, s37
  v_dot2c_f32_bf16 v22, v4, v57
  v_dot2c_f32_bf16 v23, v5, v57
  v_dot2c_f32_bf16 v30, v4, v61
  v_dot2c_f32_bf16 v31, v5, v61
  v_perm_b32 v4, v180, v176, s36
  v_perm_b32 v5, v180, v176, s37
  v_dot2c_f32_bf16 v16, v4, v58
  v_dot2c_f32_bf16 v17, v5, v58
  v_dot2c_f32_bf16 v24, v4, v62
  v_dot2c_f32_bf16 v25, v5, v62
  v_perm_b32 v4, v181, v177, s36
  v_perm_b32 v5, v181, v177, s37
  v_dot2c_f32_bf16 v18, v4, v58
  v_dot2c_f32_bf16 v19, v5, v58
  v_dot2c_f32_bf16 v26, v4, v62
  v_dot2c_f32_bf16 v27, v5, v62
  v_perm_b32 v4, v182, v178, s36
  v_perm_b32 v5, v182, v178, s37
  v_dot2c_f32_bf16 v20, v4, v58
  v_dot2c_f32_bf16 v21, v5, v58
  v_dot2c_f32_bf16 v28, v4, v62
  v_dot2c_f32_bf16 v29, v5, v62
  v_perm_b32 v4, v183, v179, s36
  v_perm_b32 v5, v183, v179, s37
  v_dot2c_f32_bf16 v22, v4, v58
  v_dot2c_f32_bf16 v23, v5, v58
  v_dot2c_f32_bf16 v30, v4, v62
  v_dot2c_f32_bf16 v31, v5, v62
  v_perm_b32 v4, v188, v184, s36
  v_perm_b32 v5, v188, v184, s37
  v_dot2c_f32_bf16 v16, v4, v59
  v_dot2c_f32_bf16 v17, v5, v59
  v_dot2c_f32_bf16 v24, v4, v63
  v_dot2c_f32_bf16 v25, v5, v63
  v_perm_b32 v4, v189, v185, s36
  v_perm_b32 v5, v189, v185, s37
  v_dot2c_f32_bf16 v18, v4, v59
  v_dot2c_f32_bf16 v19, v5, v59
  v_dot2c_f32_bf16 v26, v4, v63
  v_dot2c_f32_bf16 v27, v5, v63
  v_perm_b32 v4, v190, v186, s36
  v_perm_b32 v5, v190, v186, s37
  v_dot2c_f32_bf16 v20, v4, v59
  v_dot2c_f32_bf16 v21, v5, v59
  v_dot2c_f32_bf16 v28, v4, v63
  v_dot2c_f32_bf16 v29, v5, v63
  v_perm_b32 v4, v191, v187, s36
  v_perm_b32 v5, v191, v187, s37
  v_dot2c_f32_bf16 v22, v4, v59
  v_dot2c_f32_bf16 v23, v5, v59
  v_dot2c_f32_bf16 v30, v4, v63
  v_dot2c_f32_bf16 v31, v5, v63
  s_nop 2
  s_lshl_b32 s40, s33, 12
  v_lshlrev_b32 v10, 10, v2
  v_lshlrev_b32 v11, 5, v3
  v_add_u32 v10, v10, v11
  v_add_u32 v10, s40, v10
  s_nop 0
  ds_write_b128 v10, v[16:19] offset:0
  ds_write_b128 v10, v[20:23] offset:16
  ds_write_b128 v10, v[24:27] offset:512
  ds_write_b128 v10, v[28:31] offset:528
  s_waitcnt lgkmcnt(0)
  s_barrier
  v_lshlrev_b32 v10, 2, v0
  ds_read_b32 v32, v10 offset:0
  ds_read_b32 v33, v10 offset:1024
  ds_read_b32 v34, v10 offset:2048
  ds_read_b32 v35, v10 offset:3072
  ds_read_b32 v36, v10 offset:4096
  ds_read_b32 v37, v10 offset:5120
  ds_read_b32 v38, v10 offset:6144
  ds_read_b32 v39, v10 offset:7168
  ds_read_b32 v40, v10 offset:8192
  ds_read_b32 v41, v10 offset:9216
  ds_read_b32 v42, v10 offset:10240
  ds_read_b32 v43, v10 offset:11264
  ds_read_b32 v44, v10 offset:12288
  ds_read_b32 v45, v10 offset:13312
  ds_read_b32 v46, v10 offset:14336
  ds_read_b32 v47, v10 offset:15360
  s_waitcnt lgkmcnt(0)
  v_add_f32 v32, v32, v40
  v_add_f32 v33, v33, v41
  v_add_f32 v34, v34, v42
  v_add_f32 v35, v35, v43
  v_add_f32 v36, v36, v44
  v_add_f32 v37, v37, v45
  v_add_f32 v38, v38, v46
  v_add_f32 v39, v39, v47
  v_add_f32 v32, v32, v36
  v_add_f32 v33, v33, v37
  v_add_f32 v34, v34, v38
  v_add_f32 v35, v35, v39
  v_add_f32 v32, v32, v34
  v_add_f32 v33, v33, v35
  v_add_f32 v32, v32, v33
  v_cvt_pk_bf16_f32 v32, v32, v32
  v_lshlrev_b32 v10, 1, v0
  ds_write_b16 v10, v32 offset:32768
  s_waitcnt lgkmcnt(0)
  s_barrier
  v_and_b32 v10, 1, v1
  v_lshlrev_b32 v10, 8, v10
  v_lshlrev_b32 v11, 4, v2
  v_add_u32 v10, v10, v11
  ds_read_b128 v[32:35], v10 offset:32768
  ds_read_b128 v[36:39], v10 offset:32832
  ds_read_b128 v[40:43], v10 offset:32896
  ds_read_b128 v[44:47], v10 offset:32960
  v_mov_b32 v16, 0
  v_mov_b32 v17, 0
  v_mov_b32 v18, 0
  v_mov_b32 v19, 0
  v_mov_b32 v20, 0
  v_mov_b32 v21, 0
  v_mov_b32 v22, 0
  v_mov_b32 v23, 0
  s_waitcnt lgkmcnt(0)
  v_mfma_f32_16x16x32_bf16 v[16:19], v[192:195], v[32:35], v[16:19]
  v_mfma_f32_16x16x32_bf16 v[20:23], v[208:211], v[32:35], v[20:23]
  v_mfma_f32_16x16x32_bf16 v[16:19], v[196:199], v[36:39], v[16:19]
  v_mfma_f32_16x16x32_bf16 v[20:23], v[212:215], v[36:39], v[20:23]
  v_mfma_f32_16x16x32_bf16 v[16:19], v[200:203], v[40:43], v[16:19]
  v_mfma_f32_16x16x32_bf16 v[20:23], v[216:219], v[40:43], v[20:23]
  v_mfma_f32_16x16x32_bf16 v[16:19], v[204:207], v[44:47], v[16:19]
  v_mfma_f32_16x16x32_bf16 v[20:23], v[220:223], v[44:47], v[20:23]
  s_cmp_lg_u32 s33, 0
  s_cbranch_scc1 Lfwd_7
  s_mov_b32 s38, 200000
  v_and_b32 v4, 7, v1
  v_lshlrev_b32 v4, 2, v4
Lfw_6:
  global_load_dword v5, v4, s[28:29] sc1
  s_waitcnt vmcnt(0)
  v_cmp_ne_u32 vcc, 16, v5
  s_cbranch_vccz Lfwd_7
  s_sub_u32 s38, s38, 1
  s_cmp_eq_u32 s38, 0
  s_cbranch_scc1 Lfwd_7
  s_sleep 8
  s_branch Lfw_6
Lfwd_7:
  s_barrier
  s_lshl_b32 s40, s34, 10
  s_lshl_b32 s41, s35, 8
  s_add_u32 s40, s40, s41
  s_lshl_b32 s41, s33, 6
  s_add_u32 s40, s40, s41
  v_lshlrev_b32 v10, 15, v3
  v_lshlrev_b32 v11, 3, v2
  v_add_u32 v10, v10, v11
  v_add_u32 v10, s40, v10
  s_nop 7
  v_cvt_pk_bf16_f32 v4, v16, v17
  v_cvt_pk_bf16_f32 v5, v18, v19
  v_cvt_pk_bf16_f32 v6, v20, v21
  v_cvt_pk_bf16_f32 v7, v22, v23
  v_min_u32 v4, -2, v4
  v_min_u32 v5, -2, v5
  v_min_u32 v6, -2, v6
  v_min_u32 v7, -2, v7
  v_cmp_gt_u32 vcc, 2, v3
  s_and_saveexec_b64 s[48:49], vcc
  global_store_dwordx2 v10, v[4:5], s[30:31] offset:0 sc1
  global_store_dwordx2 v10, v[6:7], s[30:31] offset:32 sc1
  s_mov_b64 exec, s[48:49]
  s_lshl_b32 s40, s35, 20
  s_lshl_b32 s42, s33, 18
  s_add_u32 s40, s40, s42
  s_lshl_b32 s41, s34, 8
  s_add_u32 s40, s40, s41
  v_lshlrev_b32 v10, 16, v2
  v_lshlrev_b32 v11, 4, v3
  v_add_u32 v10, v10, v11
  v_add_u32 v10, s40, v10
  global_load_dwordx4 v[224:227], v10, s[12:13]
  v_add_u32 v10, 0x2000, v10
  global_load_dwordx4 v[228:231], v10, s[12:13]
  v_add_u32 v10, 0x2000, v10
  global_load_dwordx4 v[232:235], v10, s[12:13]
  v_add_u32 v10, 0x2000, v10
  global_load_dwordx4 v[236:239], v10, s[12:13]
  v_add_u32 v10, 0x2000, v10
  global_load_dwordx4 v[240:243], v10, s[12:13]
  v_add_u32 v10, 0x2000, v10
  global_load_dwordx4 v[244:247], v10, s[12:13]
  v_add_u32 v10, 0x2000, v10
  global_load_dwordx4 v[248:251], v10, s[12:13]
  v_add_u32 v10, 0x2000, v10
  global_load_dwordx4 v[252:255], v10, s[12:13]
  s_lshl_b32 s40, s34, 17
  s_lshl_b32 s41, s33, 13
  s_add_u32 s40, s40, s41
  v_lshlrev_b32 v13, 4, v1
  v_add_u32 v13, s40, v13
  s_lshl_b32 s42, s56, 15
  v_add_u32 v10, s42, v13
  global_load_dwordx4 v[64:67], v10, s[14:15] offset:0
  global_load_dwordx4 v[68:71], v10, s[14:15] offset:1024
  global_load_dwordx4 v[72:75], v10, s[14:15] offset:2048
  global_load_dwordx4 v[76:79], v10, s[14:15] offset:3072
  v_add_u32 v10, 0x1000, v10
  global_load_dwordx4 v[80:83], v10, s[14:15] offset:0
  global_load_dwordx4 v[84:87], v10, s[14:15] offset:1024
  global_load_dwordx4 v[88:91], v10, s[14:15] offset:2048
  global_load_dwordx4 v[92:95], v10, s[14:15] offset:3072
  s_waitcnt vmcnt(0)
  s_lshl_b32 s42, s57, 15
  v_add_u32 v10, s42, v13
  global_load_dwordx4 v[96:99], v10, s[14:15] offset:0
  global_load_dwordx4 v[100:103], v10, s[14:15] offset:1024
  global_load_dwordx4 v[104:107], v10, s[14:15] offset:2048
  global_load_dwordx4 v[108:111], v10, s[14:15] offset:3072
  v_add_u32 v10, 0x1000, v10
  global_load_dwordx4 v[112:115], v10, s[14:15] offset:0
  global_load_dwordx4 v[116:119], v10, s[14:15] offset:1024
  global_load_dwordx4 v[120:123], v10, s[14:15] offset:2048
  global_load_dwordx4 v[124:127], v10, s[14:15] offset:3072
  s_lshl_b32 s42, s58, 15
  v_add_u32 v10, s42, v13
  global_load_dwordx4 v[128:131], v10, s[14:15] offset:0
  global_load_dwordx4 v[132:135], v10, s[14:15] offset:1024
  global_load_dwordx4 v[136:139], v10, s[14:15] offset:2048
  global_load_dwordx4 v[140:143], v10, s[14:15] offset:3072
  v_add_u32 v10, 0x1000, v10
  global_load_dwordx4 v[144:147], v10, s[14:15] offset:0
  global_load_dwordx4 v[148:151], v10, s[14:15] offset:1024
  global_load_dwordx4 v[152:155], v10, s[14:15] offset:2048
  global_load_dwordx4 v[156:159], v10, s[14:15] offset:3072
  s_lshl_b32 s42, s59, 15
  v_add_u32 v10, s42, v13
  global_load_dwordx4 v[160:163], v10, s[14:15] offset:0
  global_load_dwordx4 v[164:167], v10, s[14:15] offset:1024
  global_load_dwordx4 v[168:171], v10, s[14:15] offset:2048
  global_load_dwordx4 v[172:175], v10, s[14:15] offset:3072
  v_add_u32 v10, 0x1000, v10
  global_load_dwordx4 v[176:179], v10, s[14:15] offset:0
  global_load_dwordx4 v[180:183], v10, s[14:15] offset:1024
  global_load_dwordx4 v[184:187], v10, s[14:15] offset:2048
  global_load_dwordx4 v[188:191], v10, s[14:15] offset:3072
  s_waitcnt vmcnt(0)
  v_perm_b32 v4, v228, v224, s36
  v_perm_b32 v228, v228, v224, s37
  v_mov_b32 v224, v4
  v_perm_b32 v4, v229, v225, s36
  v_perm_b32 v229, v229, v225, s37
  v_mov_b32 v225, v4
  v_perm_b32 v4, v230, v226, s36
  v_perm_b32 v230, v230, v226, s37
  v_mov_b32 v226, v4
  v_perm_b32 v4, v231, v227, s36
  v_perm_b32 v231, v231, v227, s37
  v_mov_b32 v227, v4
  v_perm_b32 v4, v236, v232, s36
  v_perm_b32 v236, v236, v232, s37
  v_mov_b32 v232, v4
  v_perm_b32 v4, v237, v233, s36
  v_perm_b32 v237, v237, v233, s37
  v_mov_b32 v233, v4
  v_perm_b32 v4, v238, v234, s36
  v_perm_b32 v238, v238, v234, s37
  v_mov_b32 v234, v4
  v_perm_b32 v4, v239, v235, s36
  v_perm_b32 v239, v239, v235, s37
  v_mov_b32 v235, v4
  v_perm_b32 v4, v244, v240, s36
  v_perm_b32 v244, v244, v240, s37
  v_mov_b32 v240, v4
  v_perm_b32 v4, v245, v241, s36
  v_perm_b32 v245, v245, v241, s37
  v_mov_b32 v241, v4
  v_perm_b32 v4, v246, v242, s36
  v_perm_b32 v246, v246, v242, s37
  v_mov_b32 v242, v4
  v_perm_b32 v4, v247, v243, s36
  v_perm_b32 v247, v247, v243, s37
  v_mov_b32 v243, v4
  v_perm_b32 v4, v252, v248, s36
  v_perm_b32 v252, v252, v248, s37
  v_mov_b32 v248, v4
  v_perm_b32 v4, v253, v249, s36
  v_perm_b32 v253, v253, v249, s37
  v_mov_b32 v249, v4
  v_perm_b32 v4, v254, v250, s36
  v_perm_b32 v254, v254, v250, s37
  v_mov_b32 v250, v4
  v_perm_b32 v4, v255, v251, s36
  v_perm_b32 v255, v255, v251, s37
  v_mov_b32 v251, v4
  v_perm_b32 v4, v68, v64, s36
  v_perm_b32 v68, v68, v64, s37
  v_mov_b32 v64, v4
  v_perm_b32 v4, v69, v65, s36
  v_perm_b32 v69, v69, v65, s37
  v_mov_b32 v65, v4
  v_perm_b32 v4, v70, v66, s36
  v_perm_b32 v70, v70, v66, s37
  v_mov_b32 v66, v4
  v_perm_b32 v4, v71, v67, s36
  v_perm_b32 v71, v71, v67, s37
  v_mov_b32 v67, v4
  v_perm_b32 v4, v76, v72, s36
  v_perm_b32 v76, v76, v72, s37
  v_mov_b32 v72, v4
  v_perm_b32 v4, v77, v73, s36
  v_perm_b32 v77, v77, v73, s37
  v_mov_b32 v73, v4
  v_perm_b32 v4, v78, v74, s36
  v_perm_b32 v78, v78, v74, s37
  v_mov_b32 v74, v4
  v_perm_b32 v4, v79, v75, s36
  v_perm_b32 v79, v79, v75, s37
  v_mov_b32 v75, v4
  v_perm_b32 v4, v84, v80, s36
  v_perm_b32 v84, v84, v80, s37
  v_mov_b32 v80, v4
  v_perm_b32 v4, v85, v81, s36
  v_perm_b32 v85, v85, v81, s37
  v_mov_b32 v81, v4
  v_perm_b32 v4, v86, v82, s36
  v_perm_b32 v86, v86, v82, s37
  v_mov_b32 v82, v4
  v_perm_b32 v4, v87, v83, s36
  v_perm_b32 v87, v87, v83, s37
  v_mov_b32 v83, v4
  v_perm_b32 v4, v92, v88, s36
  v_perm_b32 v92, v92, v88, s37
  v_mov_b32 v88, v4
  v_perm_b32 v4, v93, v89, s36
  v_perm_b32 v93, v93, v89, s37
  v_mov_b32 v89, v4
  v_perm_b32 v4, v94, v90, s36
  v_perm_b32 v94, v94, v90, s37
  v_mov_b32 v90, v4
  v_perm_b32 v4, v95, v91, s36
  v_perm_b32 v95, v95, v91, s37
  v_mov_b32 v91, v4
  v_perm_b32 v4, v100, v96, s36
  v_perm_b32 v100, v100, v96, s37
  v_mov_b32 v96, v4
  v_perm_b32 v4, v101, v97, s36
  v_perm_b32 v101, v101, v97, s37
  v_mov_b32 v97, v4
  v_perm_b32 v4, v102, v98, s36
  v_perm_b32 v102, v102, v98, s37
  v_mov_b32 v98, v4
  v_perm_b32 v4, v103, v99, s36
  v_perm_b32 v103, v103, v99, s37
  v_mov_b32 v99, v4
  v_perm_b32 v4, v108, v104, s36
  v_perm_b32 v108, v108, v104, s37
  v_mov_b32 v104, v4
  v_perm_b32 v4, v109, v105, s36
  v_perm_b32 v109, v109, v105, s37
  v_mov_b32 v105, v4
  v_perm_b32 v4, v110, v106, s36
  v_perm_b32 v110, v110, v106, s37
  v_mov_b32 v106, v4
  v_perm_b32 v4, v111, v107, s36
  v_perm_b32 v111, v111, v107, s37
  v_mov_b32 v107, v4
  v_perm_b32 v4, v116, v112, s36
  v_perm_b32 v116, v116, v112, s37
  v_mov_b32 v112, v4
  v_perm_b32 v4, v117, v113, s36
  v_perm_b32 v117, v117, v113, s37
  v_mov_b32 v113, v4
  v_perm_b32 v4, v118, v114, s36
  v_perm_b32 v118, v118, v114, s37
  v_mov_b32 v114, v4
  v_perm_b32 v4, v119, v115, s36
  v_perm_b32 v119, v119, v115, s37
  v_mov_b32 v115, v4
  v_perm_b32 v4, v124, v120, s36
  v_perm_b32 v124, v124, v120, s37
  v_mov_b32 v120, v4
  v_perm_b32 v4, v125, v121, s36
  v_perm_b32 v125, v125, v121, s37
  v_mov_b32 v121, v4
  v_perm_b32 v4, v126, v122, s36
  v_perm_b32 v126, v126, v122, s37
  v_mov_b32 v122, v4
  v_perm_b32 v4, v127, v123, s36
  v_perm_b32 v127, v127, v123, s37
  v_mov_b32 v123, v4
  v_perm_b32 v4, v132, v128, s36
  v_perm_b32 v132, v132, v128, s37
  v_mov_b32 v128, v4
  v_perm_b32 v4, v133, v129, s36
  v_perm_b32 v133, v133, v129, s37
  v_mov_b32 v129, v4
  v_perm_b32 v4, v134, v130, s36
  v_perm_b32 v134, v134, v130, s37
  v_mov_b32 v130, v4
  v_perm_b32 v4, v135, v131, s36
  v_perm_b32 v135, v135, v131, s37
  v_mov_b32 v131, v4
  v_perm_b32 v4, v140, v136, s36
  v_perm_b32 v140, v140, v136, s37
  v_mov_b32 v136, v4
  v_perm_b32 v4, v141, v137, s36
  v_perm_b32 v141, v141, v137, s37
  v_mov_b32 v137, v4
  v_perm_b32 v4, v142, v138, s36
  v_perm_b32 v142, v142, v138, s37
  v_mov_b32 v138, v4
  v_perm_b32 v4, v143, v139, s36
  v_perm_b32 v143, v143, v139, s37
  v_mov_b32 v139, v4
  v_perm_b32 v4, v148, v144, s36
  v_perm_b32 v148, v148, v144, s37
  v_mov_b32 v144, v4
  v_perm_b32 v4, v149, v145, s36
  v_perm_b32 v149, v149, v145, s37
  v_mov_b32 v145, v4
  v_perm_b32 v4, v150, v146, s36
  v_perm_b32 v150, v150, v146, s37
  v_mov_b32 v146, v4
  v_perm_b32 v4, v151, v147, s36
  v_perm_b32 v151, v151, v147, s37
  v_mov_b32 v147, v4
  v_perm_b32 v4, v156, v152, s36
  v_perm_b32 v156, v156, v152, s37
  v_mov_b32 v152, v4
  v_perm_b32 v4, v157, v153, s36
  v_perm_b32 v157, v157, v153, s37
  v_mov_b32 v153, v4
  v_perm_b32 v4, v158, v154, s36
  v_perm_b32 v158, v158, v154, s37
  v_mov_b32 v154, v4
  v_perm_b32 v4, v159, v155, s36
  v_perm_b32 v159, v159, v155, s37
  v_mov_b32 v155, v4
  v_perm_b32 v4, v164, v160, s36
  v_perm_b32 v164, v164, v160, s37
  v_mov_b32 v160, v4
  v_perm_b32 v4, v165, v161, s36
  v_perm_b32 v165, v165, v161, s37
  v_mov_b32 v161, v4
  v_perm_b32 v4, v166, v162, s36
  v_perm_b32 v166, v166, v162, s37
  v_mov_b32 v162, v4
  v_perm_b32 v4, v167, v163, s36
  v_perm_b32 v167, v167, v163, s37
  v_mov_b32 v163, v4
  v_perm_b32 v4, v172, v168, s36
  v_perm_b32 v172, v172, v168, s37
  v_mov_b32 v168, v4
  v_perm_b32 v4, v173, v169, s36
  v_perm_b32 v173, v173, v169, s37
  v_mov_b32 v169, v4
  v_perm_b32 v4, v174, v170, s36
  v_perm_b32 v174, v174, v170, s37
  v_mov_b32 v170, v4
  v_perm_b32 v4, v175, v171, s36
  v_perm_b32 v175, v175, v171, s37
  v_mov_b32 v171, v4
  v_perm_b32 v4, v180, v176, s36
  v_perm_b32 v180, v180, v176, s37
  v_mov_b32 v176, v4
  v_perm_b32 v4, v181, v177, s36
  v_perm_b32 v181, v181, v177, s37
  v_mov_b32 v177, v4
  v_perm_b32 v4, v182, v178, s36
  v_perm_b32 v182, v182, v178, s37
  v_mov_b32 v178, v4
  v_perm_b32 v4, v183, v179, s36
  v_perm_b32 v183, v183, v179, s37
  v_mov_b32 v179, v4
  v_perm_b32 v4, v188, v184, s36
  v_perm_b32 v188, v188, v184, s37
  v_mov_b32 v184, v4
  v_perm_b32 v4, v189, v185, s36
  v_perm_b32 v189, v189, v185, s37
  v_mov_b32 v185, v4
  v_perm_b32 v4, v190, v186, s36
  v_perm_b32 v190, v190, v186, s37
  v_mov_b32 v186, v4
  v_perm_b32 v4, v191, v187, s36
  v_perm_b32 v191, v191, v187, s37
  v_mov_b32 v187, v4
  s_lshr_b32 s50, s33, 1
  s_and_b32 s51, s33, 1
  s_lshl_b32 s40, s50, 5
  s_add_u32 s40, s40, s34
  s_lshl_b32 s41, s40, 9
  v_lshlrev_b32 v12, 3, v1
  v_add_u32 v12, s41, v12
  s_lshl_b32 s41, s40, 16
  s_lshl_b32 s42, s51, 15
  s_add_u32 s41, s41, s42
  s_lshl_b32 s42, s35, 8
  s_add_u32 s41, s41, s42
  s_add_u32 s41, s41, 1310720
  v_lshlrev_b32 v13, 10, v2
  v_lshlrev_b32 v11, 4, v3
  v_add_u32 v13, v13, v11
  v_add_u32 v13, s41, v13
  v_add_u32 v12, 65536, v12
  s_mov_b32 s38, 200000
Lp_8:
  global_load_dwordx2 v[48:49], v12, s[30:31] sc1
  s_waitcnt vmcnt(0)
  v_max_u32 v4, v48, v49
  v_cmp_eq_u32 vcc, -1, v4
  s_cbranch_vccz Lpd_9
  s_sub_u32 s38, s38, 1
  s_cmp_eq_u32 s38, 0
  s_cbranch_scc1 Lpd_9
  s_sleep 1
  s_branch Lp_8
Lpd_9:
  global_load_dwordx4 v[192:195], v13, s[30:31] sc1
  v_add_u32 v13, 0x1000, v13
  global_load_dwordx4 v[196:199], v13, s[30:31] sc1
  v_add_u32 v13, 0x1000, v13
  global_load_dwordx4 v[200:203], v13, s[30:31] sc1
  v_add_u32 v13, 0x1000, v13
  global_load_dwordx4 v[204:207], v13, s[30:31] sc1
  v_add_u32 v13, 0x1000, v13
  global_load_dwordx4 v[208:211], v13, s[30:31] sc1
  v_add_u32 v13, 0x1000, v13
  global_load_dwordx4 v[212:215], v13, s[30:31] sc1
  v_add_u32 v13, 0x1000, v13
  global_load_dwordx4 v[216:219], v13, s[30:31] sc1
  v_add_u32 v13, 0x1000, v13
  global_load_dwordx4 v[220:223], v13, s[30:31] sc1
  v_mov_b32 v50, v48
  s_nop 1
  v_max_f32_dpp v50, v50, v50 quad_perm:[1,0,3,2] row_mask:0xf bank_mask:0xf
  s_nop 1
  v_max_f32_dpp v50, v50, v50 quad_perm:[2,3,0,1] row_mask:0xf bank_mask:0xf
  s_nop 1
  v_max_f32_dpp v50, v50, v50 row_half_mirror row_mask:0xf bank_mask:0xf
  s_nop 1
  v_max_f32_dpp v50, v50, v50 row_mirror row_mask:0xf bank_mask:0xf
  v_mov_b32 v51, v50
  s_nop 1
  v_permlane16_swap_b32 v50, v51
  s_nop 1
  v_max_f32 v50, v50, v51
  v_mov_b32 v51, v50
  s_nop 1
  v_permlane32_swap_b32 v50, v51
  s_nop 1
  v_max_f32 v50, v50, v51
  v_sub_f32 v50, v48, v50
  v_exp_f32 v50, v50
  s_nop 0
  v_mul_f32 v52, v50, v49
  s_nop 1
  v_add_f32_dpp v52, v52, v52 quad_perm:[1,0,3,2] row_mask:0xf bank_mask:0xf
  s_nop 1
  v_add_f32_dpp v52, v52, v52 quad_perm:[2,3,0,1] row_mask:0xf bank_mask:0xf
  s_nop 1
  v_add_f32_dpp v52, v52, v52 row_half_mirror row_mask:0xf bank_mask:0xf
  s_nop 1
  v_add_f32_dpp v52, v52, v52 row_mirror row_mask:0xf bank_mask:0xf
  v_mov_b32 v51, v52
  s_nop 1
  v_permlane16_swap_b32 v52, v51
  s_nop 1
  v_add_f32 v52, v52, v51
  v_mov_b32 v51, v52
  s_nop 1
  v_permlane32_swap_b32 v52, v51
  s_nop 1
  v_add_f32 v52, v52, v51
  v_rcp_f32 v52, v52
  s_nop 0
  v_mul_f32 v50, v50, v52
  s_lshl_b32 s40, s51, 7
  v_lshlrev_b32 v10, 2, v2
  v_add_u32 v10, s40, v10
  ds_bpermute_b32 v52, v10, v50 offset:0
  ds_bpermute_b32 v53, v10, v50 offset:16
  ds_bpermute_b32 v54, v10, v50 offset:32
  ds_bpermute_b32 v55, v10, v50 offset:48
  ds_bpermute_b32 v56, v10, v50 offset:64
  ds_bpermute_b32 v57, v10, v50 offset:80
  ds_bpermute_b32 v58, v10, v50 offset:96
  ds_bpermute_b32 v59, v10, v50 offset:112
  v_mov_b32 v16, 0
  v_mov_b32 v17, 0
  v_mov_b32 v18, 0
  v_mov_b32 v19, 0
  v_mov_b32 v20, 0
  v_mov_b32 v21, 0
  v_mov_b32 v22, 0
  v_mov_b32 v23, 0
  s_waitcnt lgkmcnt(0)
  s_waitcnt vmcnt(0)
  v_lshlrev_b32 v4, 16, v192
  v_and_b32 v5, 0xffff0000, v192
  v_fmac_f32 v16, v52, v4
  v_fmac_f32 v17, v52, v5
  v_lshlrev_b32 v4, 16, v193
  v_and_b32 v5, 0xffff0000, v193
  v_fmac_f32 v18, v52, v4
  v_fmac_f32 v19, v52, v5
  v_lshlrev_b32 v4, 16, v194
  v_and_b32 v5, 0xffff0000, v194
  v_fmac_f32 v20, v52, v4
  v_fmac_f32 v21, v52, v5
  v_lshlrev_b32 v4, 16, v195
  v_and_b32 v5, 0xffff0000, v195
  v_fmac_f32 v22, v52, v4
  v_fmac_f32 v23, v52, v5
  v_lshlrev_b32 v4, 16, v196
  v_and_b32 v5, 0xffff0000, v196
  v_fmac_f32 v16, v53, v4
  v_fmac_f32 v17, v53, v5
  v_lshlrev_b32 v4, 16, v197
  v_and_b32 v5, 0xffff0000, v197
  v_fmac_f32 v18, v53, v4
  v_fmac_f32 v19, v53, v5
  v_lshlrev_b32 v4, 16, v198
  v_and_b32 v5, 0xffff0000, v198
  v_fmac_f32 v20, v53, v4
  v_fmac_f32 v21, v53, v5
  v_lshlrev_b32 v4, 16, v199
  v_and_b32 v5, 0xffff0000, v199
  v_fmac_f32 v22, v53, v4
  v_fmac_f32 v23, v53, v5
  v_lshlrev_b32 v4, 16, v200
  v_and_b32 v5, 0xffff0000, v200
  v_fmac_f32 v16, v54, v4
  v_fmac_f32 v17, v54, v5
  v_lshlrev_b32 v4, 16, v201
  v_and_b32 v5, 0xffff0000, v201
  v_fmac_f32 v18, v54, v4
  v_fmac_f32 v19, v54, v5
  v_lshlrev_b32 v4, 16, v202
  v_and_b32 v5, 0xffff0000, v202
  v_fmac_f32 v20, v54, v4
  v_fmac_f32 v21, v54, v5
  v_lshlrev_b32 v4, 16, v203
  v_and_b32 v5, 0xffff0000, v203
  v_fmac_f32 v22, v54, v4
  v_fmac_f32 v23, v54, v5
  v_lshlrev_b32 v4, 16, v204
  v_and_b32 v5, 0xffff0000, v204
  v_fmac_f32 v16, v55, v4
  v_fmac_f32 v17, v55, v5
  v_lshlrev_b32 v4, 16, v205
  v_and_b32 v5, 0xffff0000, v205
  v_fmac_f32 v18, v55, v4
  v_fmac_f32 v19, v55, v5
  v_lshlrev_b32 v4, 16, v206
  v_and_b32 v5, 0xffff0000, v206
  v_fmac_f32 v20, v55, v4
  v_fmac_f32 v21, v55, v5
  v_lshlrev_b32 v4, 16, v207
  v_and_b32 v5, 0xffff0000, v207
  v_fmac_f32 v22, v55, v4
  v_fmac_f32 v23, v55, v5
  v_lshlrev_b32 v4, 16, v208
  v_and_b32 v5, 0xffff0000, v208
  v_fmac_f32 v16, v56, v4
  v_fmac_f32 v17, v56, v5
  v_lshlrev_b32 v4, 16, v209
  v_and_b32 v5, 0xffff0000, v209
  v_fmac_f32 v18, v56, v4
  v_fmac_f32 v19, v56, v5
  v_lshlrev_b32 v4, 16, v210
  v_and_b32 v5, 0xffff0000, v210
  v_fmac_f32 v20, v56, v4
  v_fmac_f32 v21, v56, v5
  v_lshlrev_b32 v4, 16, v211
  v_and_b32 v5, 0xffff0000, v211
  v_fmac_f32 v22, v56, v4
  v_fmac_f32 v23, v56, v5
  v_lshlrev_b32 v4, 16, v212
  v_and_b32 v5, 0xffff0000, v212
  v_fmac_f32 v16, v57, v4
  v_fmac_f32 v17, v57, v5
  v_lshlrev_b32 v4, 16, v213
  v_and_b32 v5, 0xffff0000, v213
  v_fmac_f32 v18, v57, v4
  v_fmac_f32 v19, v57, v5
  v_lshlrev_b32 v4, 16, v214
  v_and_b32 v5, 0xffff0000, v214
  v_fmac_f32 v20, v57, v4
  v_fmac_f32 v21, v57, v5
  v_lshlrev_b32 v4, 16, v215
  v_and_b32 v5, 0xffff0000, v215
  v_fmac_f32 v22, v57, v4
  v_fmac_f32 v23, v57, v5
  v_lshlrev_b32 v4, 16, v216
  v_and_b32 v5, 0xffff0000, v216
  v_fmac_f32 v16, v58, v4
  v_fmac_f32 v17, v58, v5
  v_lshlrev_b32 v4, 16, v217
  v_and_b32 v5, 0xffff0000, v217
  v_fmac_f32 v18, v58, v4
  v_fmac_f32 v19, v58, v5
  v_lshlrev_b32 v4, 16, v218
  v_and_b32 v5, 0xffff0000, v218
  v_fmac_f32 v20, v58, v4
  v_fmac_f32 v21, v58, v5
  v_lshlrev_b32 v4, 16, v219
  v_and_b32 v5, 0xffff0000, v219
  v_fmac_f32 v22, v58, v4
  v_fmac_f32 v23, v58, v5
  v_lshlrev_b32 v4, 16, v220
  v_and_b32 v5, 0xffff0000, v220
  v_fmac_f32 v16, v59, v4
  v_fmac_f32 v17, v59, v5
  v_lshlrev_b32 v4, 16, v221
  v_and_b32 v5, 0xffff0000, v221
  v_fmac_f32 v18, v59, v4
  v_fmac_f32 v19, v59, v5
  v_lshlrev_b32 v4, 16, v222
  v_and_b32 v5, 0xffff0000, v222
  v_fmac_f32 v20, v59, v4
  v_fmac_f32 v21, v59, v5
  v_lshlrev_b32 v4, 16, v223
  v_and_b32 v5, 0xffff0000, v223
  v_fmac_f32 v22, v59, v4
  v_fmac_f32 v23, v59, v5
  s_lshl_b32 s40, s33, 11
  v_lshlrev_b32 v10, 9, v2
  v_lshlrev_b32 v11, 5, v3
  v_add_u32 v10, v10, v11
  v_add_u32 v10, s40, v10
  ds_write_b128 v10, v[16:19] offset:0
  ds_write_b128 v10, v[20:23] offset:16
  s_waitcnt lgkmcnt(0)
  s_barrier
  v_lshrrev_b32 v10, 7, v0
  v_lshlrev_b32 v10, 12, v10
  v_and_b32 v11, 127, v0
  v_lshlrev_b32 v11, 2, v11
  v_add_u32 v10, v10, v11
  ds_read_b32 v48, v10 offset:0
  ds_read_b32 v49, v10 offset:512
  ds_read_b32 v50, v10 offset:1024
  ds_read_b32 v51, v10 offset:1536
  ds_read_b32 v52, v10 offset:2048
  ds_read_b32 v53, v10 offset:2560
  ds_read_b32 v54, v10 offset:3072
  ds_read_b32 v55, v10 offset:3584
  s_waitcnt lgkmcnt(0)
  v_add_f32 v48, v48, v52
  v_add_f32 v49, v49, v53
  v_add_f32 v50, v50, v54
  v_add_f32 v51, v51, v55
  v_add_f32 v48, v48, v50
  v_add_f32 v49, v49, v51
  v_add_f32 v48, v48, v49
  v_cvt_pk_bf16_f32 v48, v48, v48
  v_lshlrev_b32 v10, 1, v0
  ds_write_b16 v10, v48 offset:33280
  s_waitcnt lgkmcnt(0)
  s_barrier
  s_lshl_b32 s40, s33, 6
  v_lshlrev_b32 v10, 4, v2
  v_add_u32 v10, s40, v10
  ds_read_b128 v[48:51], v10 offset:33280
  ds_read_b128 v[52:55], v10 offset:33536
  v_mov_b32 v16, 0
  v_mov_b32 v17, 0
  v_mov_b32 v18, 0
  v_mov_b32 v19, 0
  v_mov_b32 v20, 0
  v_mov_b32 v21, 0
  v_mov_b32 v22, 0
  v_mov_b32 v23, 0
  v_mov_b32 v24, 0
  v_mov_b32 v25, 0
  v_mov_b32 v26, 0
  v_mov_b32 v27, 0
  v_mov_b32 v28, 0
  v_mov_b32 v29, 0
  v_mov_b32 v30, 0
  v_mov_b32 v31, 0
  s_waitcnt lgkmcnt(0)
  v_dot2c_f32_bf16 v16, v224, v48
  v_dot2c_f32_bf16 v17, v228, v48
  v_dot2c_f32_bf16 v24, v224, v52
  v_dot2c_f32_bf16 v25, v228, v52
  v_dot2c_f32_bf16 v18, v225, v48
  v_dot2c_f32_bf16 v19, v229, v48
  v_dot2c_f32_bf16 v26, v225, v52
  v_dot2c_f32_bf16 v27, v229, v52
  v_dot2c_f32_bf16 v20, v226, v48
  v_dot2c_f32_bf16 v21, v230, v48
  v_dot2c_f32_bf16 v28, v226, v52
  v_dot2c_f32_bf16 v29, v230, v52
  v_dot2c_f32_bf16 v22, v227, v48
  v_dot2c_f32_bf16 v23, v231, v48
  v_dot2c_f32_bf16 v30, v227, v52
  v_dot2c_f32_bf16 v31, v231, v52
  v_dot2c_f32_bf16 v16, v232, v49
  v_dot2c_f32_bf16 v17, v236, v49
  v_dot2c_f32_bf16 v24, v232, v53
  v_dot2c_f32_bf16 v25, v236, v53
  v_dot2c_f32_bf16 v18, v233, v49
  v_dot2c_f32_bf16 v19, v237, v49
  v_dot2c_f32_bf16 v26, v233, v53
  v_dot2c_f32_bf16 v27, v237, v53
  v_dot2c_f32_bf16 v20, v234, v49
  v_dot2c_f32_bf16 v21, v238, v49
  v_dot2c_f32_bf16 v28, v234, v53
  v_dot2c_f32_bf16 v29, v238, v53
  v_dot2c_f32_bf16 v22, v235, v49
  v_dot2c_f32_bf16 v23, v239, v49
  v_dot2c_f32_bf16 v30, v235, v53
  v_dot2c_f32_bf16 v31, v239, v53
  v_dot2c_f32_bf16 v16, v240, v50
  v_dot2c_f32_bf16 v17, v244, v50
  v_dot2c_f32_bf16 v24, v240, v54
  v_dot2c_f32_bf16 v25, v244, v54
  v_dot2c_f32_bf16 v18, v241, v50
  v_dot2c_f32_bf16 v19, v245, v50
  v_dot2c_f32_bf16 v26, v241, v54
  v_dot2c_f32_bf16 v27, v245, v54
  v_dot2c_f32_bf16 v20, v242, v50
  v_dot2c_f32_bf16 v21, v246, v50
  v_dot2c_f32_bf16 v28, v242, v54
  v_dot2c_f32_bf16 v29, v246, v54
  v_dot2c_f32_bf16 v22, v243, v50
  v_dot2c_f32_bf16 v23, v247, v50
  v_dot2c_f32_bf16 v30, v243, v54
  v_dot2c_f32_bf16 v31, v247, v54
  v_dot2c_f32_bf16 v16, v248, v51
  v_dot2c_f32_bf16 v17, v252, v51
  v_dot2c_f32_bf16 v24, v248, v55
  v_dot2c_f32_bf16 v25, v252, v55
  v_dot2c_f32_bf16 v18, v249, v51
  v_dot2c_f32_bf16 v19, v253, v51
  v_dot2c_f32_bf16 v26, v249, v55
  v_dot2c_f32_bf16 v27, v253, v55
  v_dot2c_f32_bf16 v20, v250, v51
  v_dot2c_f32_bf16 v21, v254, v51
  v_dot2c_f32_bf16 v28, v250, v55
  v_dot2c_f32_bf16 v29, v254, v55
  v_dot2c_f32_bf16 v22, v251, v51
  v_dot2c_f32_bf16 v23, v255, v51
  v_dot2c_f32_bf16 v30, v251, v55
  v_dot2c_f32_bf16 v31, v255, v55
  s_nop 2
  s_lshl_b32 s40, s33, 12
  v_lshlrev_b32 v10, 10, v2
  v_lshlrev_b32 v11, 5, v3
  v_add_u32 v10, v10, v11
  v_add_u32 v10, s40, v10
  s_nop 0
  ds_write_b128 v10, v[16:19] offset:0
  ds_write_b128 v10, v[20:23] offset:16
  ds_write_b128 v10, v[24:27] offset:512
  ds_write_b128 v10, v[28:31] offset:528
  s_waitcnt lgkmcnt(0)
  s_barrier
  v_lshlrev_b32 v10, 2, v0
  ds_read_b32 v192, v10 offset:0
  ds_read_b32 v193, v10 offset:1024
  ds_read_b32 v194, v10 offset:2048
  ds_read_b32 v195, v10 offset:3072
  ds_read_b32 v196, v10 offset:4096
  ds_read_b32 v197, v10 offset:5120
  ds_read_b32 v198, v10 offset:6144
  ds_read_b32 v199, v10 offset:7168
  ds_read_b32 v200, v10 offset:8192
  ds_read_b32 v201, v10 offset:9216
  ds_read_b32 v202, v10 offset:10240
  ds_read_b32 v203, v10 offset:11264
  ds_read_b32 v204, v10 offset:12288
  ds_read_b32 v205, v10 offset:13312
  ds_read_b32 v206, v10 offset:14336
  ds_read_b32 v207, v10 offset:15360
  s_waitcnt lgkmcnt(0)
  v_add_f32 v192, v192, v200
  v_add_f32 v193, v193, v201
  v_add_f32 v194, v194, v202
  v_add_f32 v195, v195, v203
  v_add_f32 v196, v196, v204
  v_add_f32 v197, v197, v205
  v_add_f32 v198, v198, v206
  v_add_f32 v199, v199, v207
  v_add_f32 v192, v192, v196
  v_add_f32 v193, v193, v197
  v_add_f32 v194, v194, v198
  v_add_f32 v195, v195, v199
  v_add_f32 v192, v192, v194
  v_add_f32 v193, v193, v195
  v_add_f32 v192, v192, v193
  v_cvt_pk_bf16_f32 v192, v192, v192
  v_lshlrev_b32 v10, 1, v0
  ds_write_b16 v10, v192 offset:33792
  s_waitcnt lgkmcnt(0)
  s_barrier
  s_lshl_b32 s40, s33, 4
  s_lshl_b32 s41, s56, 6
  s_add_u32 s41, s41, s40
  v_mov_b32 v10, s41
  ds_read_b128 v[192:195], v10 offset:33792
  ds_read_b128 v[196:199], v10 offset:34048
  s_lshl_b32 s41, s57, 6
  s_add_u32 s41, s41, s40
  v_mov_b32 v10, s41
  ds_read_b128 v[200:203], v10 offset:33792
  ds_read_b128 v[204:207], v10 offset:34048
  s_lshl_b32 s41, s58, 6
  s_add_u32 s41, s41, s40
  v_mov_b32 v10, s41
  ds_read_b128 v[208:211], v10 offset:33792
  ds_read_b128 v[212:215], v10 offset:34048
  s_lshl_b32 s41, s59, 6
  s_add_u32 s41, s41, s40
  v_mov_b32 v10, s41
  ds_read_b128 v[216:219], v10 offset:33792
  ds_read_b128 v[220:223], v10 offset:34048
  v_mov_b32 v16, 0
  v_mov_b32 v17, 0
  v_mov_b32 v18, 0
  v_mov_b32 v19, 0
  v_mov_b32 v20, 0
  v_mov_b32 v21, 0
  v_mov_b32 v22, 0
  v_mov_b32 v23, 0
  v_mov_b32 v24, 0
  v_mov_b32 v25, 0
  v_mov_b32 v26, 0
  v_mov_b32 v27, 0
  v_mov_b32 v28, 0
  v_mov_b32 v29, 0
  v_mov_b32 v30, 0
  v_mov_b32 v31, 0
  s_waitcnt lgkmcnt(0)
  v_dot2c_f32_bf16 v16, v64, v192
  v_dot2c_f32_bf16 v17, v68, v192
  v_dot2c_f32_bf16 v24, v64, v196
  v_dot2c_f32_bf16 v25, v68, v196
  v_dot2c_f32_bf16 v18, v65, v192
  v_dot2c_f32_bf16 v19, v69, v192
  v_dot2c_f32_bf16 v26, v65, v196
  v_dot2c_f32_bf16 v27, v69, v196
  v_dot2c_f32_bf16 v20, v66, v192
  v_dot2c_f32_bf16 v21, v70, v192
  v_dot2c_f32_bf16 v28, v66, v196
  v_dot2c_f32_bf16 v29, v70, v196
  v_dot2c_f32_bf16 v22, v67, v192
  v_dot2c_f32_bf16 v23, v71, v192
  v_dot2c_f32_bf16 v30, v67, v196
  v_dot2c_f32_bf16 v31, v71, v196
  v_dot2c_f32_bf16 v16, v72, v193
  v_dot2c_f32_bf16 v17, v76, v193
  v_dot2c_f32_bf16 v24, v72, v197
  v_dot2c_f32_bf16 v25, v76, v197
  v_dot2c_f32_bf16 v18, v73, v193
  v_dot2c_f32_bf16 v19, v77, v193
  v_dot2c_f32_bf16 v26, v73, v197
  v_dot2c_f32_bf16 v27, v77, v197
  v_dot2c_f32_bf16 v20, v74, v193
  v_dot2c_f32_bf16 v21, v78, v193
  v_dot2c_f32_bf16 v28, v74, v197
  v_dot2c_f32_bf16 v29, v78, v197
  v_dot2c_f32_bf16 v22, v75, v193
  v_dot2c_f32_bf16 v23, v79, v193
  v_dot2c_f32_bf16 v30, v75, v197
  v_dot2c_f32_bf16 v31, v79, v197
  v_dot2c_f32_bf16 v16, v80, v194
  v_dot2c_f32_bf16 v17, v84, v194
  v_dot2c_f32_bf16 v24, v80, v198
  v_dot2c_f32_bf16 v25, v84, v198
  v_dot2c_f32_bf16 v18, v81, v194
  v_dot2c_f32_bf16 v19, v85, v194
  v_dot2c_f32_bf16 v26, v81, v198
  v_dot2c_f32_bf16 v27, v85, v198
  v_dot2c_f32_bf16 v20, v82, v194
  v_dot2c_f32_bf16 v21, v86, v194
  v_dot2c_f32_bf16 v28, v82, v198
  v_dot2c_f32_bf16 v29, v86, v198
  v_dot2c_f32_bf16 v22, v83, v194
  v_dot2c_f32_bf16 v23, v87, v194
  v_dot2c_f32_bf16 v30, v83, v198
  v_dot2c_f32_bf16 v31, v87, v198
  v_dot2c_f32_bf16 v16, v88, v195
  v_dot2c_f32_bf16 v17, v92, v195
  v_dot2c_f32_bf16 v24, v88, v199
  v_dot2c_f32_bf16 v25, v92, v199
  v_dot2c_f32_bf16 v18, v89, v195
  v_dot2c_f32_bf16 v19, v93, v195
  v_dot2c_f32_bf16 v26, v89, v199
  v_dot2c_f32_bf16 v27, v93, v199
  v_dot2c_f32_bf16 v20, v90, v195
  v_dot2c_f32_bf16 v21, v94, v195
  v_dot2c_f32_bf16 v28, v90, v199
  v_dot2c_f32_bf16 v29, v94, v199
  v_dot2c_f32_bf16 v22, v91, v195
  v_dot2c_f32_bf16 v23, v95, v195
  v_dot2c_f32_bf16 v30, v91, v199
  v_dot2c_f32_bf16 v31, v95, v199
  v_dot2c_f32_bf16 v16, v96, v200
  v_dot2c_f32_bf16 v17, v100, v200
  v_dot2c_f32_bf16 v24, v96, v204
  v_dot2c_f32_bf16 v25, v100, v204
  v_dot2c_f32_bf16 v18, v97, v200
  v_dot2c_f32_bf16 v19, v101, v200
  v_dot2c_f32_bf16 v26, v97, v204
  v_dot2c_f32_bf16 v27, v101, v204
  v_dot2c_f32_bf16 v20, v98, v200
  v_dot2c_f32_bf16 v21, v102, v200
  v_dot2c_f32_bf16 v28, v98, v204
  v_dot2c_f32_bf16 v29, v102, v204
  v_dot2c_f32_bf16 v22, v99, v200
  v_dot2c_f32_bf16 v23, v103, v200
  v_dot2c_f32_bf16 v30, v99, v204
  v_dot2c_f32_bf16 v31, v103, v204
  v_dot2c_f32_bf16 v16, v104, v201
  v_dot2c_f32_bf16 v17, v108, v201
  v_dot2c_f32_bf16 v24, v104, v205
  v_dot2c_f32_bf16 v25, v108, v205
  v_dot2c_f32_bf16 v18, v105, v201
  v_dot2c_f32_bf16 v19, v109, v201
  v_dot2c_f32_bf16 v26, v105, v205
  v_dot2c_f32_bf16 v27, v109, v205
  v_dot2c_f32_bf16 v20, v106, v201
  v_dot2c_f32_bf16 v21, v110, v201
  v_dot2c_f32_bf16 v28, v106, v205
  v_dot2c_f32_bf16 v29, v110, v205
  v_dot2c_f32_bf16 v22, v107, v201
  v_dot2c_f32_bf16 v23, v111, v201
  v_dot2c_f32_bf16 v30, v107, v205
  v_dot2c_f32_bf16 v31, v111, v205
  v_dot2c_f32_bf16 v16, v112, v202
  v_dot2c_f32_bf16 v17, v116, v202
  v_dot2c_f32_bf16 v24, v112, v206
  v_dot2c_f32_bf16 v25, v116, v206
  v_dot2c_f32_bf16 v18, v113, v202
  v_dot2c_f32_bf16 v19, v117, v202
  v_dot2c_f32_bf16 v26, v113, v206
  v_dot2c_f32_bf16 v27, v117, v206
  v_dot2c_f32_bf16 v20, v114, v202
  v_dot2c_f32_bf16 v21, v118, v202
  v_dot2c_f32_bf16 v28, v114, v206
  v_dot2c_f32_bf16 v29, v118, v206
  v_dot2c_f32_bf16 v22, v115, v202
  v_dot2c_f32_bf16 v23, v119, v202
  v_dot2c_f32_bf16 v30, v115, v206
  v_dot2c_f32_bf16 v31, v119, v206
  v_dot2c_f32_bf16 v16, v120, v203
  v_dot2c_f32_bf16 v17, v124, v203
  v_dot2c_f32_bf16 v24, v120, v207
  v_dot2c_f32_bf16 v25, v124, v207
  v_dot2c_f32_bf16 v18, v121, v203
  v_dot2c_f32_bf16 v19, v125, v203
  v_dot2c_f32_bf16 v26, v121, v207
  v_dot2c_f32_bf16 v27, v125, v207
  v_dot2c_f32_bf16 v20, v122, v203
  v_dot2c_f32_bf16 v21, v126, v203
  v_dot2c_f32_bf16 v28, v122, v207
  v_dot2c_f32_bf16 v29, v126, v207
  v_dot2c_f32_bf16 v22, v123, v203
  v_dot2c_f32_bf16 v23, v127, v203
  v_dot2c_f32_bf16 v30, v123, v207
  v_dot2c_f32_bf16 v31, v127, v207
  v_dot2c_f32_bf16 v16, v128, v208
  v_dot2c_f32_bf16 v17, v132, v208
  v_dot2c_f32_bf16 v24, v128, v212
  v_dot2c_f32_bf16 v25, v132, v212
  v_dot2c_f32_bf16 v18, v129, v208
  v_dot2c_f32_bf16 v19, v133, v208
  v_dot2c_f32_bf16 v26, v129, v212
  v_dot2c_f32_bf16 v27, v133, v212
  v_dot2c_f32_bf16 v20, v130, v208
  v_dot2c_f32_bf16 v21, v134, v208
  v_dot2c_f32_bf16 v28, v130, v212
  v_dot2c_f32_bf16 v29, v134, v212
  v_dot2c_f32_bf16 v22, v131, v208
  v_dot2c_f32_bf16 v23, v135, v208
  v_dot2c_f32_bf16 v30, v131, v212
  v_dot2c_f32_bf16 v31, v135, v212
  v_dot2c_f32_bf16 v16, v136, v209
  v_dot2c_f32_bf16 v17, v140, v209
  v_dot2c_f32_bf16 v24, v136, v213
  v_dot2c_f32_bf16 v25, v140, v213
  v_dot2c_f32_bf16 v18, v137, v209
  v_dot2c_f32_bf16 v19, v141, v209
  v_dot2c_f32_bf16 v26, v137, v213
  v_dot2c_f32_bf16 v27, v141, v213
  v_dot2c_f32_bf16 v20, v138, v209
  v_dot2c_f32_bf16 v21, v142, v209
  v_dot2c_f32_bf16 v28, v138, v213
  v_dot2c_f32_bf16 v29, v142, v213
  v_dot2c_f32_bf16 v22, v139, v209
  v_dot2c_f32_bf16 v23, v143, v209
  v_dot2c_f32_bf16 v30, v139, v213
  v_dot2c_f32_bf16 v31, v143, v213
  v_dot2c_f32_bf16 v16, v144, v210
  v_dot2c_f32_bf16 v17, v148, v210
  v_dot2c_f32_bf16 v24, v144, v214
  v_dot2c_f32_bf16 v25, v148, v214
  v_dot2c_f32_bf16 v18, v145, v210
  v_dot2c_f32_bf16 v19, v149, v210
  v_dot2c_f32_bf16 v26, v145, v214
  v_dot2c_f32_bf16 v27, v149, v214
  v_dot2c_f32_bf16 v20, v146, v210
  v_dot2c_f32_bf16 v21, v150, v210
  v_dot2c_f32_bf16 v28, v146, v214
  v_dot2c_f32_bf16 v29, v150, v214
  v_dot2c_f32_bf16 v22, v147, v210
  v_dot2c_f32_bf16 v23, v151, v210
  v_dot2c_f32_bf16 v30, v147, v214
  v_dot2c_f32_bf16 v31, v151, v214
  v_dot2c_f32_bf16 v16, v152, v211
  v_dot2c_f32_bf16 v17, v156, v211
  v_dot2c_f32_bf16 v24, v152, v215
  v_dot2c_f32_bf16 v25, v156, v215
  v_dot2c_f32_bf16 v18, v153, v211
  v_dot2c_f32_bf16 v19, v157, v211
  v_dot2c_f32_bf16 v26, v153, v215
  v_dot2c_f32_bf16 v27, v157, v215
  v_dot2c_f32_bf16 v20, v154, v211
  v_dot2c_f32_bf16 v21, v158, v211
  v_dot2c_f32_bf16 v28, v154, v215
  v_dot2c_f32_bf16 v29, v158, v215
  v_dot2c_f32_bf16 v22, v155, v211
  v_dot2c_f32_bf16 v23, v159, v211
  v_dot2c_f32_bf16 v30, v155, v215
  v_dot2c_f32_bf16 v31, v159, v215
  v_dot2c_f32_bf16 v16, v160, v216
  v_dot2c_f32_bf16 v17, v164, v216
  v_dot2c_f32_bf16 v24, v160, v220
  v_dot2c_f32_bf16 v25, v164, v220
  v_dot2c_f32_bf16 v18, v161, v216
  v_dot2c_f32_bf16 v19, v165, v216
  v_dot2c_f32_bf16 v26, v161, v220
  v_dot2c_f32_bf16 v27, v165, v220
  v_dot2c_f32_bf16 v20, v162, v216
  v_dot2c_f32_bf16 v21, v166, v216
  v_dot2c_f32_bf16 v28, v162, v220
  v_dot2c_f32_bf16 v29, v166, v220
  v_dot2c_f32_bf16 v22, v163, v216
  v_dot2c_f32_bf16 v23, v167, v216
  v_dot2c_f32_bf16 v30, v163, v220
  v_dot2c_f32_bf16 v31, v167, v220
  v_dot2c_f32_bf16 v16, v168, v217
  v_dot2c_f32_bf16 v17, v172, v217
  v_dot2c_f32_bf16 v24, v168, v221
  v_dot2c_f32_bf16 v25, v172, v221
  v_dot2c_f32_bf16 v18, v169, v217
  v_dot2c_f32_bf16 v19, v173, v217
  v_dot2c_f32_bf16 v26, v169, v221
  v_dot2c_f32_bf16 v27, v173, v221
  v_dot2c_f32_bf16 v20, v170, v217
  v_dot2c_f32_bf16 v21, v174, v217
  v_dot2c_f32_bf16 v28, v170, v221
  v_dot2c_f32_bf16 v29, v174, v221
  v_dot2c_f32_bf16 v22, v171, v217
  v_dot2c_f32_bf16 v23, v175, v217
  v_dot2c_f32_bf16 v30, v171, v221
  v_dot2c_f32_bf16 v31, v175, v221
  v_dot2c_f32_bf16 v16, v176, v218
  v_dot2c_f32_bf16 v17, v180, v218
  v_dot2c_f32_bf16 v24, v176, v222
  v_dot2c_f32_bf16 v25, v180, v222
  v_dot2c_f32_bf16 v18, v177, v218
  v_dot2c_f32_bf16 v19, v181, v218
  v_dot2c_f32_bf16 v26, v177, v222
  v_dot2c_f32_bf16 v27, v181, v222
  v_dot2c_f32_bf16 v20, v178, v218
  v_dot2c_f32_bf16 v21, v182, v218
  v_dot2c_f32_bf16 v28, v178, v222
  v_dot2c_f32_bf16 v29, v182, v222
  v_dot2c_f32_bf16 v22, v179, v218
  v_dot2c_f32_bf16 v23, v183, v218
  v_dot2c_f32_bf16 v30, v179, v222
  v_dot2c_f32_bf16 v31, v183, v222
  v_dot2c_f32_bf16 v16, v184, v219
  v_dot2c_f32_bf16 v17, v188, v219
  v_dot2c_f32_bf16 v24, v184, v223
  v_dot2c_f32_bf16 v25, v188, v223
  v_dot2c_f32_bf16 v18, v185, v219
  v_dot2c_f32_bf16 v19, v189, v219
  v_dot2c_f32_bf16 v26, v185, v223
  v_dot2c_f32_bf16 v27, v189, v223
  v_dot2c_f32_bf16 v20, v186, v219
  v_dot2c_f32_bf16 v21, v190, v219
  v_dot2c_f32_bf16 v28, v186, v223
  v_dot2c_f32_bf16 v29, v190, v223
  v_dot2c_f32_bf16 v22, v187, v219
  v_dot2c_f32_bf16 v23, v191, v219
  v_dot2c_f32_bf16 v30, v187, v223
  v_dot2c_f32_bf16 v31, v191, v223
  s_nop 2
  s_lshl_b32 s40, s33, 12
  v_lshlrev_b32 v10, 5, v1
  v_add_u32 v10, s40, v10
  s_nop 1
  ds_write_b128 v10, v[16:19] offset:0
  ds_write_b128 v10, v[20:23] offset:16
  ds_write_b128 v10, v[24:27] offset:2048
  ds_write_b128 v10, v[28:31] offset:2064
  s_waitcnt lgkmcnt(0)
  s_barrier
  v_lshlrev_b32 v10, 4, v0
  ds_read_b128 v[16:19], v10 offset:0
  ds_read_b128 v[20:23], v10 offset:4096
  ds_read_b128 v[24:27], v10 offset:8192
  ds_read_b128 v[28:31], v10 offset:12288
  s_waitcnt lgkmcnt(0)
  v_add_f32 v16, v16, v20
  v_add_f32 v24, v24, v28
  v_add_f32 v17, v17, v21
  v_add_f32 v25, v25, v29
  v_add_f32 v18, v18, v22
  v_add_f32 v26, v26, v30
  v_add_f32 v19, v19, v23
  v_add_f32 v27, v27, v31
  v_add_f32 v16, v16, v24
  v_min_u32 v16, -2, v16
  v_add_f32 v17, v17, v25
  v_min_u32 v17, -2, v17
  v_add_f32 v18, v18, v26
  v_min_u32 v18, -2, v18
  v_add_f32 v19, v19, v27
  v_min_u32 v19, -2, v19
  s_lshl_b32 s40, s52, 12
  s_add_u32 s40, s40, 262144
  v_add_u32 v10, s40, v10
  global_store_dwordx4 v10, v[16:19], s[30:31] sc1
  s_endpgm
role_a:
  s_sub_u32 s52, s2, 128
  s_lshr_b32 s50, s52, 6
  s_and_b32 s51, s52, 63
  s_cmp_lg_u32 s33, 3
  s_cbranch_scc1 Lsvc_10
  v_mov_b32 v4, -1
  v_mov_b32 v5, -1
  v_mov_b32 v6, -1
  v_mov_b32 v7, -1
  v_lshlrev_b32 v8, 4, v1
  s_lshl_b32 s40, s52, 13
  s_add_u32 s40, s40, 262144
  v_add_u32 v9, s40, v8
  global_store_dwordx4 v9, v[4:7], s[30:31] offset:0 sc1
  global_store_dwordx4 v9, v[4:7], s[30:31] offset:1024 sc1
  global_store_dwordx4 v9, v[4:7], s[30:31] offset:2048 sc1
  global_store_dwordx4 v9, v[4:7], s[30:31] offset:3072 sc1
  v_add_u32 v9, 0x1000, v9
  global_store_dwordx4 v9, v[4:7], s[30:31] offset:0 sc1
  global_store_dwordx4 v9, v[4:7], s[30:31] offset:1024 sc1
  global_store_dwordx4 v9, v[4:7], s[30:31] offset:2048 sc1
  global_store_dwordx4 v9, v[4:7], s[30:31] offset:3072 sc1
  s_mul_i32 s40, s52, 1792
  v_add_u32 v9, s40, v8
  global_store_dwordx4 v9, v[4:7], s[30:31] sc1
  v_cmp_gt_u32 vcc, 48, v1
  s_and_saveexec_b64 s[48:49], vcc
  global_store_dwordx4 v9, v[4:7], s[30:31] offset:1024 sc1
  s_mov_b64 exec, s[48:49]
  s_waitcnt vmcnt(0)
  v_cmp_eq_u32 vcc, 0, v1
  s_and_saveexec_b64 s[48:49], vcc
  s_and_b32 s40, s52, 7
  s_lshl_b32 s40, s40, 2
  v_mov_b32 v4, s40
  v_mov_b32 v5, 1
  global_atomic_add v4, v5, s[28:29] sc1
  s_mov_b64 exec, s[48:49]
Lsvc_10:
  s_barrier
  s_lshl_b32 s40, s50, 23
  s_lshl_b32 s41, s51, 17
  s_add_u32 s40, s40, s41
  s_lshl_b32 s41, s33, 15
  s_add_u32 s40, s40, s41
  s_add_u32 s54, s6, s40
  s_addc_u32 s55, s7, 0
  s_add_u32 s56, s54, 16384
  s_addc_u32 s57, s55, 0
  v_xor_b32 v16, 0, v1
  v_lshlrev_b32 v16, 4, v16
  v_xor_b32 v17, 4, v1
  v_lshlrev_b32 v17, 4, v17
  v_xor_b32 v18, 8, v1
  v_lshlrev_b32 v18, 4, v18
  v_xor_b32 v19, 12, v1
  v_lshlrev_b32 v19, 4, v19
  v_xor_b32 v20, 1, v1
  v_lshlrev_b32 v20, 4, v20
  v_add_u32 v20, 4096, v20
  v_xor_b32 v21, 5, v1
  v_lshlrev_b32 v21, 4, v21
  v_add_u32 v21, 4096, v21
  v_xor_b32 v22, 9, v1
  v_lshlrev_b32 v22, 4, v22
  v_add_u32 v22, 4096, v22
  v_xor_b32 v23, 13, v1
  v_lshlrev_b32 v23, 4, v23
  v_add_u32 v23, 4096, v23
  v_xor_b32 v24, 2, v1
  v_lshlrev_b32 v24, 4, v24
  v_add_u32 v24, 8192, v24
  v_xor_b32 v25, 6, v1
  v_lshlrev_b32 v25, 4, v25
  v_add_u32 v25, 8192, v25
  v_xor_b32 v26, 10, v1
  v_lshlrev_b32 v26, 4, v26
  v_add_u32 v26, 8192, v26
  v_xor_b32 v27, 14, v1
  v_lshlrev_b32 v27, 4, v27
  v_add_u32 v27, 8192, v27
  v_xor_b32 v28, 3, v1
  v_lshlrev_b32 v28, 4, v28
  v_add_u32 v28, 12288, v28
  v_xor_b32 v29, 7, v1
  v_lshlrev_b32 v29, 4, v29
  v_add_u32 v29, 12288, v29
  v_xor_b32 v30, 11, v1
  v_lshlrev_b32 v30, 4, v30
  v_add_u32 v30, 12288, v30
  v_xor_b32 v31, 15, v1
  v_lshlrev_b32 v31, 4, v31
  v_add_u32 v31, 12288, v31
  s_lshl_b32 s40, s33, 15
  s_add_u32 s41, s40, 32768
  s_mov_b32 m0, s41
  s_nop 0
  global_load_lds_dwordx4 v16, s[54:55] offset:0
  global_load_lds_dwordx4 v17, s[54:55] offset:1024
  global_load_lds_dwordx4 v18, s[54:55] offset:2048
  global_load_lds_dwordx4 v19, s[54:55] offset:3072
  s_waitcnt vmcnt(12)
  s_add_u32 s41, s40, 36864
  s_mov_b32 m0, s41
  s_nop 0
  global_load_lds_dwordx4 v20, s[54:55] offset:0
  global_load_lds_dwordx4 v21, s[54:55] offset:1024
  global_load_lds_dwordx4 v22, s[54:55] offset:2048
  global_load_lds_dwordx4 v23, s[54:55] offset:3072
  s_waitcnt vmcnt(12)
  s_add_u32 s41, s40, 40960
  s_mov_b32 m0, s41
  s_nop 0
  global_load_lds_dwordx4 v24, s[54:55] offset:0
  global_load_lds_dwordx4 v25, s[54:55] offset:1024
  global_load_lds_dwordx4 v26, s[54:55] offset:2048
  global_load_lds_dwordx4 v27, s[54:55] offset:3072
  s_waitcnt vmcnt(12)
  s_add_u32 s41, s40, 45056
  s_mov_b32 m0, s41
  s_nop 0
  global_load_lds_dwordx4 v28, s[54:55] offset:0
  global_load_lds_dwordx4 v29, s[54:55] offset:1024
  global_load_lds_dwordx4 v30, s[54:55] offset:2048
  global_load_lds_dwordx4 v31, s[54:55] offset:3072
  s_waitcnt vmcnt(12)
  s_add_u32 s41, s40, 49152
  s_mov_b32 m0, s41
  s_nop 0
  global_load_lds_dwordx4 v16, s[56:57] offset:0
  global_load_lds_dwordx4 v17, s[56:57] offset:1024
  global_load_lds_dwordx4 v18, s[56:57] offset:2048
  global_load_lds_dwordx4 v19, s[56:57] offset:3072
  s_waitcnt vmcnt(12)
  s_add_u32 s41, s40, 53248
  s_mov_b32 m0, s41
  s_nop 0
  global_load_lds_dwordx4 v20, s[56:57] offset:0
  global_load_lds_dwordx4 v21, s[56:57] offset:1024
  global_load_lds_dwordx4 v22, s[56:57] offset:2048
  global_load_lds_dwordx4 v23, s[56:57] offset:3072
  s_waitcnt vmcnt(12)
  s_add_u32 s41, s40, 57344
  s_mov_b32 m0, s41
  s_nop 0
  global_load_lds_dwordx4 v24, s[56:57] offset:0
  global_load_lds_dwordx4 v25, s[56:57] offset:1024
  global_load_lds_dwordx4 v26, s[56:57] offset:2048
  global_load_lds_dwordx4 v27, s[56:57] offset:3072
  s_waitcnt vmcnt(12)
  s_add_u32 s41, s40, 61440
  s_mov_b32 m0, s41
  s_nop 0
  global_load_lds_dwordx4 v28, s[56:57] offset:0
  global_load_lds_dwordx4 v29, s[56:57] offset:1024
  global_load_lds_dwordx4 v30, s[56:57] offset:2048
  global_load_lds_dwordx4 v31, s[56:57] offset:3072
  s_waitcnt vmcnt(12)
  s_lshr_b32 s40, s52, 4
  s_lshl_b32 s40, s40, 10
  v_lshlrev_b32 v10, 4, v1
  v_add_u32 v11, s40, v10
  global_load_dwordx4 v[240:243], v11, s[4:5]
  global_load_dwordx4 v[244:247], v10, s[24:25]
  s_waitcnt vmcnt(0)
  v_mov_b32 v248, 0
  v_dot2c_f32_bf16 v248, v240, v244
  v_dot2c_f32_bf16 v248, v241, v245
  v_dot2c_f32_bf16 v248, v242, v246
  v_dot2c_f32_bf16 v248, v243, v247
  s_nop 2
  s_nop 1
  v_add_f32_dpp v248, v248, v248 quad_perm:[1,0,3,2] row_mask:0xf bank_mask:0xf
  s_nop 1
  v_add_f32_dpp v248, v248, v248 quad_perm:[2,3,0,1] row_mask:0xf bank_mask:0xf
  s_nop 1
  v_add_f32_dpp v248, v248, v248 row_half_mirror row_mask:0xf bank_mask:0xf
  s_nop 1
  v_add_f32_dpp v248, v248, v248 row_mirror row_mask:0xf bank_mask:0xf
  v_mov_b32 v249, v248
  s_nop 1
  v_permlane16_swap_b32 v248, v249
  s_nop 1
  v_add_f32 v248, v248, v249
  v_mov_b32 v249, v248
  s_nop 1
  v_permlane32_swap_b32 v248, v249
  s_nop 1
  v_add_f32 v248, v248, v249
  v_mul_f32 v248, 0xbfb8aa3b, v248
  v_exp_f32 v248, v248
  s_nop 0
  v_add_f32 v248, 1.0, v248
  v_rcp_f32 v248, v248
  s_nop 1
  v_readfirstlane_b32 s60, v248
  s_cmp_lg_u32 s33, 0
  s_cbranch_scc1 Lfwd_12
  s_mov_b32 s38, 200000
  v_and_b32 v4, 7, v1
  v_lshlrev_b32 v4, 2, v4
Lfw_11:
  global_load_dword v5, v4, s[28:29] sc1
  s_waitcnt vmcnt(0)
  v_cmp_ne_u32 vcc, 16, v5
  s_cbranch_vccz Lfwd_12
  s_sub_u32 s38, s38, 1
  s_cmp_eq_u32 s38, 0
  s_cbranch_scc1 Lfwd_12
  s_sleep 8
  s_branch Lfw_11
Lfwd_12:
  s_barrier
  s_lshl_b32 s40, s50, 15
  v_lshlrev_b32 v12, 4, v0
  v_add_u32 v12, s40, v12
  s_lshl_b32 s41, s33, 10
  s_add_u32 s41, s41, s40
  v_and_b32 v10, 31, v1
  v_lshlrev_b32 v11, 8, v10
  v_lshrrev_b32 v10, 2, v10
  v_mul_u32_u24 v10, 3072, v10
  v_add_u32 v10, v10, v11
  v_add_u32 v10, s41, v10
  v_add_u32 v10, 252, v10
  s_mov_b32 s38, 200000
Llp_13:
  global_load_dword v4, v10, s[30:31] sc1
  s_waitcnt vmcnt(0)
  v_cmp_eq_u32 vcc, -1, v4
  s_cbranch_vccz Llpd_14
  s_sub_u32 s38, s38, 1
  s_cmp_eq_u32 s38, 0
  s_cbranch_scc1 Llpd_14
  s_sleep 6
  s_branch Llp_13
Llpd_14:
  s_mov_b32 s38, 200000
Lp_15:
  v_mov_b32 v10, v12
  global_load_dwordx4 v[64:67], v10, s[30:31] sc1
  v_add_u32 v10, 0x1000, v10
  global_load_dwordx4 v[68:71], v10, s[30:31] sc1
  v_add_u32 v10, 0x1000, v10
  global_load_dwordx4 v[72:75], v10, s[30:31] sc1
  v_add_u32 v10, 0x1000, v10
  global_load_dwordx4 v[76:79], v10, s[30:31] sc1
  v_add_u32 v10, 0x1000, v10
  global_load_dwordx4 v[80:83], v10, s[30:31] sc1
  v_add_u32 v10, 0x1000, v10
  global_load_dwordx4 v[84:87], v10, s[30:31] sc1
  v_add_u32 v10, 0x1000, v10
  global_load_dwordx4 v[88:91], v10, s[30:31] sc1
  v_add_u32 v10, 0x1000, v10
  global_load_dwordx4 v[92:95], v10, s[30:31] sc1
  s_waitcnt vmcnt(0)
  v_max_u32 v4, v64, v65
  v_max3_u32 v4, v4, v66, v67
  v_max3_u32 v4, v4, v68, v69
  v_max3_u32 v4, v4, v70, v71
  v_max3_u32 v4, v4, v72, v73
  v_max3_u32 v4, v4, v74, v75
  v_max3_u32 v4, v4, v76, v77
  v_max3_u32 v4, v4, v78, v79
  v_max3_u32 v4, v4, v80, v81
  v_max3_u32 v4, v4, v82, v83
  v_max3_u32 v4, v4, v84, v85
  v_max3_u32 v4, v4, v86, v87
  v_max3_u32 v4, v4, v88, v89
  v_max3_u32 v4, v4, v90, v91
  v_max3_u32 v4, v4, v92, v93
  v_max3_u32 v4, v4, v94, v95
  v_cmp_eq_u32 vcc, -1, v4
  s_cbranch_vccz Lpd_16
  s_sub_u32 s38, s38, 1
  s_cmp_eq_u32 s38, 0
  s_cbranch_scc1 Lpd_16
  s_sleep 1
  s_branch Lp_15
Lpd_16:
  s_lshl_b32 s40, s33, 2
  s_lshl_b32 s41, s33, 10
  s_add_u32 s41, s41, 0
  v_xor_b32 v4, 0, v1
  v_xor_b32 v4, s40, v4
  v_lshlrev_b32 v4, 4, v4
  v_add_u32 v4, s41, v4
  v_xor_b32 v5, 1, v1
  v_xor_b32 v5, s40, v5
  v_lshlrev_b32 v5, 4, v5
  v_add_u32 v5, s41, v5
  v_xor_b32 v6, 2, v1
  v_xor_b32 v6, s40, v6
  v_lshlrev_b32 v6, 4, v6
  v_add_u32 v6, s41, v6
  v_xor_b32 v7, 3, v1
  v_xor_b32 v7, s40, v7
  v_lshlrev_b32 v7, 4, v7
  v_add_u32 v7, s41, v7
  ds_write_b128 v4, v[64:67] offset:0
  ds_write_b128 v5, v[68:71] offset:4096
  ds_write_b128 v6, v[72:75] offset:8192
  ds_write_b128 v7, v[76:79] offset:12288
  ds_write_b128 v4, v[80:83] offset:16384
  ds_write_b128 v5, v[84:87] offset:20480
  ds_write_b128 v6, v[88:91] offset:24576
  ds_write_b128 v7, v[92:95] offset:28672
  s_waitcnt lgkmcnt(0)
  s_barrier
  v_and_b32 v4, 31, v1
  v_lshrrev_b32 v5, 5, v1
  v_and_b32 v6, 3, v1
  v_lshlrev_b32 v6, 2, v6
  v_lshrrev_b32 v7, 2, v1
  v_and_b32 v7, 3, v7
  v_or_b32 v6, v6, v7
  v_lshlrev_b32 v4, 10, v4
  s_lshl_b32 s40, s33, 15
  s_add_u32 s40, s40, 32768
  v_add_u32 v7, 0, v5
  v_xor_b32 v7, v7, v6
  v_lshlrev_b32 v7, 4, v7
  v_add_u32 v7, v7, v4
  v_add_u32 v16, s40, v7
  v_add_u32 v24, 0, v7
  v_add_u32 v7, 2, v5
  v_xor_b32 v7, v7, v6
  v_lshlrev_b32 v7, 4, v7
  v_add_u32 v7, v7, v4
  v_add_u32 v17, s40, v7
  v_add_u32 v25, 0, v7
  v_add_u32 v7, 4, v5
  v_xor_b32 v7, v7, v6
  v_lshlrev_b32 v7, 4, v7
  v_add_u32 v7, v7, v4
  v_add_u32 v18, s40, v7
  v_add_u32 v26, 0, v7
  v_add_u32 v7, 6, v5
  v_xor_b32 v7, v7, v6
  v_lshlrev_b32 v7, 4, v7
  v_add_u32 v7, v7, v4
  v_add_u32 v19, s40, v7
  v_add_u32 v27, 0, v7
  v_add_u32 v7, 8, v5
  v_xor_b32 v7, v7, v6
  v_lshlrev_b32 v7, 4, v7
  v_add_u32 v7, v7, v4
  v_add_u32 v20, s40, v7
  v_add_u32 v28, 0, v7
  v_add_u32 v7, 10, v5
  v_xor_b32 v7, v7, v6
  v_lshlrev_b32 v7, 4, v7
  v_add_u32 v7, v7, v4
  v_add_u32 v21, s40, v7
  v_add_u32 v29, 0, v7
  v_add_u32 v7, 12, v5
  v_xor_b32 v7, v7, v6
  v_lshlrev_b32 v7, 4, v7
  v_add_u32 v7, v7, v4
  v_add_u32 v22, s40, v7
  v_add_u32 v30, 0, v7
  v_add_u32 v7, 14, v5
  v_xor_b32 v7, v7, v6
  v_lshlrev_b32 v7, 4, v7
  v_add_u32 v7, v7, v4
  v_add_u32 v23, s40, v7
  v_add_u32 v31, 0, v7
  v_mov_b32 v32, 0
  v_mov_b32 v33, 0
  v_mov_b32 v34, 0
  v_mov_b32 v35, 0
  v_mov_b32 v36, 0
  v_mov_b32 v37, 0
  v_mov_b32 v38, 0
  v_mov_b32 v39, 0
  v_mov_b32 v40, 0
  v_mov_b32 v41, 0
  v_mov_b32 v42, 0
  v_mov_b32 v43, 0
  v_mov_b32 v44, 0
  v_mov_b32 v45, 0
  v_mov_b32 v46, 0
  v_mov_b32 v47, 0
  ds_read_b128 v[96:99], v16 offset:0
  ds_read_b128 v[100:103], v24 offset:0
  ds_read_b128 v[104:107], v17 offset:0
  ds_read_b128 v[108:111], v25 offset:0
  ds_read_b128 v[112:115], v18 offset:0
  ds_read_b128 v[116:119], v26 offset:0
  ds_read_b128 v[120:123], v19 offset:0
  ds_read_b128 v[124:127], v27 offset:0
  s_waitcnt lgkmcnt(6)
  v_mfma_f32_32x32x16_bf16 v[32:47], v[96:99], v[100:103], v[32:47]
  ds_read_b128 v[96:99], v20 offset:0
  ds_read_b128 v[100:103], v28 offset:0
  s_waitcnt lgkmcnt(6)
  v_mfma_f32_32x32x16_bf16 v[32:47], v[104:107], v[108:111], v[32:47]
  ds_read_b128 v[104:107], v21 offset:0
  ds_read_b128 v[108:111], v29 offset:0
  s_waitcnt lgkmcnt(6)
  v_mfma_f32_32x32x16_bf16 v[32:47], v[112:115], v[116:119], v[32:47]
  ds_read_b128 v[112:115], v22 offset:0
  ds_read_b128 v[116:119], v30 offset:0
  s_waitcnt lgkmcnt(6)
  v_mfma_f32_32x32x16_bf16 v[32:47], v[120:123], v[124:127], v[32:47]
  ds_read_b128 v[120:123], v23 offset:0
  ds_read_b128 v[124:127], v31 offset:0
  s_waitcnt lgkmcnt(6)
  v_mfma_f32_32x32x16_bf16 v[32:47], v[96:99], v[100:103], v[32:47]
  ds_read_b128 v[96:99], v16 offset:256
  ds_read_b128 v[100:103], v24 offset:256
  s_waitcnt lgkmcnt(6)
  v_mfma_f32_32x32x16_bf16 v[32:47], v[104:107], v[108:111], v[32:47]
  ds_read_b128 v[104:107], v17 offset:256
  ds_read_b128 v[108:111], v25 offset:256
  s_waitcnt lgkmcnt(6)
  v_mfma_f32_32x32x16_bf16 v[32:47], v[112:115], v[116:119], v[32:47]
  ds_read_b128 v[112:115], v18 offset:256
  ds_read_b128 v[116:119], v26 offset:256
  s_waitcnt lgkmcnt(6)
  v_mfma_f32_32x32x16_bf16 v[32:47], v[120:123], v[124:127], v[32:47]
  ds_read_b128 v[120:123], v19 offset:256
  ds_read_b128 v[124:127], v27 offset:256
  s_waitcnt lgkmcnt(6)
  v_mfma_f32_32x32x16_bf16 v[32:47], v[96:99], v[100:103], v[32:47]
  ds_read_b128 v[96:99], v20 offset:256
  ds_read_b128 v[100:103], v28 offset:256
  s_waitcnt lgkmcnt(6)
  v_mfma_f32_32x32x16_bf16 v[32:47], v[104:107], v[108:111], v[32:47]
  ds_read_b128 v[104:107], v21 offset:256
  ds_read_b128 v[108:111], v29 offset:256
  s_waitcnt lgkmcnt(6)
  v_mfma_f32_32x32x16_bf16 v[32:47], v[112:115], v[116:119], v[32:47]
  ds_read_b128 v[112:115], v22 offset:256
  ds_read_b128 v[116:119], v30 offset:256
  s_waitcnt lgkmcnt(6)
  v_mfma_f32_32x32x16_bf16 v[32:47], v[120:123], v[124:127], v[32:47]
  ds_read_b128 v[120:123], v23 offset:256
  ds_read_b128 v[124:127], v31 offset:256
  s_waitcnt lgkmcnt(6)
  v_mfma_f32_32x32x16_bf16 v[32:47], v[96:99], v[100:103], v[32:47]
  ds_read_b128 v[96:99], v16 offset:512
  ds_read_b128 v[100:103], v24 offset:512
  s_waitcnt lgkmcnt(6)
  v_mfma_f32_32x32x16_bf16 v[32:47], v[104:107], v[108:111], v[32:47]
  ds_read_b128 v[104:107], v17 offset:512
  ds_read_b128 v[108:111], v25 offset:512
  s_waitcnt lgkmcnt(6)
  v_mfma_f32_32x32x16_bf16 v[32:47], v[112:115], v[116:119], v[32:47]
  ds_read_b128 v[112:115], v18 offset:512
  ds_read_b128 v[116:119], v26 offset:512
  s_waitcnt lgkmcnt(6)
  v_mfma_f32_32x32x16_bf16 v[32:47], v[120:123], v[124:127], v[32:47]
  ds_read_b128 v[120:123], v19 offset:512
  ds_read_b128 v[124:127], v27 offset:512
  s_waitcnt lgkmcnt(6)
  v_mfma_f32_32x32x16_bf16 v[32:47], v[96:99], v[100:103], v[32:47]
  ds_read_b128 v[96:99], v20 offset:512
  ds_read_b128 v[100:103], v28 offset:512
  s_waitcnt lgkmcnt(6)
  v_mfma_f32_32x32x16_bf16 v[32:47], v[104:107], v[108:111], v[32:47]
  ds_read_b128 v[104:107], v21 offset:512
  ds_read_b128 v[108:111], v29 offset:512
  s_waitcnt lgkmcnt(6)
  v_mfma_f32_32x32x16_bf16 v[32:47], v[112:115], v[116:119], v[32:47]
  ds_read_b128 v[112:115], v22 offset:512
  ds_read_b128 v[116:119], v30 offset:512
  s_waitcnt lgkmcnt(6)
  v_mfma_f32_32x32x16_bf16 v[32:47], v[120:123], v[124:127], v[32:47]
  ds_read_b128 v[120:123], v23 offset:512
  ds_read_b128 v[124:127], v31 offset:512
  s_waitcnt lgkmcnt(6)
  v_mfma_f32_32x32x16_bf16 v[32:47], v[96:99], v[100:103], v[32:47]
  ds_read_b128 v[96:99], v16 offset:768
  ds_read_b128 v[100:103], v24 offset:768
  s_waitcnt lgkmcnt(6)
  v_mfma_f32_32x32x16_bf16 v[32:47], v[104:107], v[108:111], v[32:47]
  ds_read_b128 v[104:107], v17 offset:768
  ds_read_b128 v[108:111], v25 offset:768
  s_waitcnt lgkmcnt(6)
  v_mfma_f32_32x32x16_bf16 v[32:47], v[112:115], v[116:119], v[32:47]
  ds_read_b128 v[112:115], v18 offset:768
  ds_read_b128 v[116:119], v26 offset:768
  s_waitcnt lgkmcnt(6)
  v_mfma_f32_32x32x16_bf16 v[32:47], v[120:123], v[124:127], v[32:47]
  ds_read_b128 v[120:123], v19 offset:768
  ds_read_b128 v[124:127], v27 offset:768
  s_waitcnt lgkmcnt(6)
  v_mfma_f32_32x32x16_bf16 v[32:47], v[96:99], v[100:103], v[32:47]
  ds_read_b128 v[96:99], v20 offset:768
  ds_read_b128 v[100:103], v28 offset:768
  s_waitcnt lgkmcnt(6)
  v_mfma_f32_32x32x16_bf16 v[32:47], v[104:107], v[108:111], v[32:47]
  ds_read_b128 v[104:107], v21 offset:768
  ds_read_b128 v[108:111], v29 offset:768
  s_waitcnt lgkmcnt(6)
  v_mfma_f32_32x32x16_bf16 v[32:47], v[112:115], v[116:119], v[32:47]
  ds_read_b128 v[112:115], v22 offset:768
  ds_read_b128 v[116:119], v30 offset:768
  s_waitcnt lgkmcnt(6)
  v_mfma_f32_32x32x16_bf16 v[32:47], v[120:123], v[124:127], v[32:47]
  ds_read_b128 v[120:123], v23 offset:768
  ds_read_b128 v[124:127], v31 offset:768
  s_waitcnt lgkmcnt(6)
  v_mfma_f32_32x32x16_bf16 v[32:47], v[96:99], v[100:103], v[32:47]
  s_waitcnt lgkmcnt(4)
  v_mfma_f32_32x32x16_bf16 v[32:47], v[104:107], v[108:111], v[32:47]
  s_waitcnt lgkmcnt(2)
  v_mfma_f32_32x32x16_bf16 v[32:47], v[112:115], v[116:119], v[32:47]
  s_waitcnt lgkmcnt(0)
  v_mfma_f32_32x32x16_bf16 v[32:47], v[120:123], v[124:127], v[32:47]
  s_barrier
  s_nop 11
  v_max3_f32 v4, v32, v33, v34
  v_max3_f32 v4, v4, v35, v36
  v_max3_f32 v4, v4, v37, v38
  v_max3_f32 v4, v4, v39, v40
  v_max3_f32 v4, v4, v41, v42
  v_max3_f32 v4, v4, v43, v44
  v_max3_f32 v4, v4, v45, v46
  v_max_f32 v4, v4, v47
  v_mov_b32 v5, v4
  s_nop 1
  v_permlane32_swap_b32 v4, v5
  s_nop 1
  v_max_f32 v4, v4, v5
  v_and_b32 v6, 31, v1
  v_lshlrev_b32 v6, 2, v6
  v_add_u32 v6, 0, v6
  s_lshl_b32 s40, s33, 7
  v_add_u32 v7, s40, v6
  ds_write_b32 v7, v4 offset:8192
  s_waitcnt lgkmcnt(0)
  s_barrier
  ds_read_b32 v8, v6 offset:8192
  ds_read_b32 v9, v6 offset:8320
  ds_read_b32 v10, v6 offset:8448
  ds_read_b32 v11, v6 offset:8576
  s_waitcnt lgkmcnt(0)
  v_max3_f32 v8, v8, v9, v10
  v_max_f32 v8, v8, v11
  s_mov_b32 s41, 0x3e0293ee
  v_mul_f32 v8, s41, v8
  v_fma_f32 v32, v32, s41, -v8
  v_fma_f32 v33, v33, s41, -v8
  v_fma_f32 v34, v34, s41, -v8
  v_fma_f32 v35, v35, s41, -v8
  v_fma_f32 v36, v36, s41, -v8
  v_fma_f32 v37, v37, s41, -v8
  v_fma_f32 v38, v38, s41, -v8
  v_fma_f32 v39, v39, s41, -v8
  v_fma_f32 v40, v40, s41, -v8
  v_fma_f32 v41, v41, s41, -v8
  v_fma_f32 v42, v42, s41, -v8
  v_fma_f32 v43, v43, s41, -v8
  v_fma_f32 v44, v44, s41, -v8
  v_fma_f32 v45, v45, s41, -v8
  v_fma_f32 v46, v46, s41, -v8
  v_fma_f32 v47, v47, s41, -v8
  v_exp_f32 v32, v32
  v_exp_f32 v33, v33
  v_exp_f32 v34, v34
  v_exp_f32 v35, v35
  v_exp_f32 v36, v36
  v_exp_f32 v37, v37
  v_exp_f32 v38, v38
  v_exp_f32 v39, v39
  v_exp_f32 v40, v40
  v_exp_f32 v41, v41
  v_exp_f32 v42, v42
  v_exp_f32 v43, v43
  v_exp_f32 v44, v44
  v_exp_f32 v45, v45
  v_exp_f32 v46, v46
  v_exp_f32 v47, v47
  s_nop 0
  v_add_f32 v9, v32, v33
  v_add_f32 v9, v9, v34
  v_add_f32 v9, v9, v35
  v_add_f32 v9, v9, v36
  v_add_f32 v9, v9, v37
  v_add_f32 v9, v9, v38
  v_add_f32 v9, v9, v39
  v_add_f32 v9, v9, v40
  v_add_f32 v9, v9, v41
  v_add_f32 v9, v9, v42
  v_add_f32 v9, v9, v43
  v_add_f32 v9, v9, v44
  v_add_f32 v9, v9, v45
  v_add_f32 v9, v9, v46
  v_add_f32 v9, v9, v47
  v_mov_b32 v10, v9
  s_nop 1
  v_permlane32_swap_b32 v9, v10
  s_nop 1
  v_add_f32 v9, v9, v10
  ds_write_b32 v7, v9 offset:8704
  v_cvt_pk_bf16_f32 v12, v32, v33
  v_cvt_pk_bf16_f32 v13, v34, v35
  v_cvt_pk_bf16_f32 v14, v36, v37
  v_cvt_pk_bf16_f32 v15, v38, v39
  v_cvt_pk_bf16_f32 v32, v40, v41
  v_cvt_pk_bf16_f32 v33, v42, v43
  v_cvt_pk_bf16_f32 v34, v44, v45
  v_cvt_pk_bf16_f32 v35, v46, v47
  s_lshl_b32 s40, s33, 11
  v_lshlrev_b32 v11, 4, v1
  v_add_u32 v11, 0, v11
  v_add_u32 v7, s40, v11
  ds_write_b128 v7, v[12:15] offset:0
  ds_write_b128 v7, v[32:35] offset:1024
  s_waitcnt lgkmcnt(0)
  s_barrier
  ds_read_b128 v[128:131], v11 offset:0
  ds_read_b128 v[132:135], v11 offset:1024
  ds_read_b128 v[136:139], v11 offset:2048
  ds_read_b128 v[140:143], v11 offset:3072
  ds_read_b128 v[144:147], v11 offset:4096
  ds_read_b128 v[148:151], v11 offset:5120
  ds_read_b128 v[152:155], v11 offset:6144
  ds_read_b128 v[156:159], v11 offset:7168
  ds_read_b32 v12, v6 offset:8704
  ds_read_b32 v13, v6 offset:8832
  ds_read_b32 v14, v6 offset:8960
  ds_read_b32 v15, v6 offset:9088
  s_waitcnt lgkmcnt(0)
  v_add_f32 v12, v12, v13
  v_add_f32 v14, v14, v15
  v_add_f32 v9, v12, v14
  v_mov_b32 v2, v8
  v_mov_b32 v3, v9
  v_lshrrev_b32 v4, 2, v1
  v_and_b32 v4, 3, v4
  v_lshrrev_b32 v5, 4, v1
  v_and_b32 v5, 1, v5
  v_lshlrev_b32 v5, 1, v5
  v_lshrrev_b32 v6, 1, v1
  v_and_b32 v6, 1, v6
  v_or_b32 v5, v5, v6
  v_lshrrev_b32 v6, 5, v1
  v_and_b32 v7, 1, v1
  v_lshlrev_b32 v7, 3, v7
  v_lshlrev_b32 v8, 2, v6
  v_add_u32 v8, v8, v4
  v_lshlrev_b32 v8, 10, v8
  v_add_u32 v8, v8, v7
  s_lshl_b32 s40, s33, 8
  s_add_u32 s40, s40, 32768
  v_add_u32 v8, s40, v8
  v_xor_b32 v9, 0, v4
  v_lshlrev_b32 v9, 2, v9
  v_add_u32 v10, 0, v6
  v_xor_b32 v10, v10, v5
  v_or_b32 v9, v9, v10
  v_lshlrev_b32 v9, 4, v9
  v_add_u32 v9, v9, v8
  v_add_u32 v16, 0, v9
  v_add_u32 v24, 65536, v9
  v_xor_b32 v9, 0, v4
  v_lshlrev_b32 v9, 2, v9
  v_add_u32 v10, 2, v6
  v_xor_b32 v10, v10, v5
  v_or_b32 v9, v9, v10
  v_lshlrev_b32 v9, 4, v9
  v_add_u32 v9, v9, v8
  v_add_u32 v17, 8192, v9
  v_add_u32 v25, 73728, v9
  v_xor_b32 v9, 1, v4
  v_lshlrev_b32 v9, 2, v9
  v_add_u32 v10, 0, v6
  v_xor_b32 v10, v10, v5
  v_or_b32 v9, v9, v10
  v_lshlrev_b32 v9, 4, v9
  v_add_u32 v9, v9, v8
  v_add_u32 v18, 0, v9
  v_add_u32 v26, 65536, v9
  v_xor_b32 v9, 1, v4
  v_lshlrev_b32 v9, 2, v9
  v_add_u32 v10, 2, v6
  v_xor_b32 v10, v10, v5
  v_or_b32 v9, v9, v10
  v_lshlrev_b32 v9, 4, v9
  v_add_u32 v9, v9, v8
  v_add_u32 v19, 8192, v9
  v_add_u32 v27, 73728, v9
  v_xor_b32 v9, 2, v4
  v_lshlrev_b32 v9, 2, v9
  v_add_u32 v10, 0, v6
  v_xor_b32 v10, v10, v5
  v_or_b32 v9, v9, v10
  v_lshlrev_b32 v9, 4, v9
  v_add_u32 v9, v9, v8
  v_add_u32 v20, 0, v9
  v_add_u32 v28, 65536, v9
  v_xor_b32 v9, 2, v4
  v_lshlrev_b32 v9, 2, v9
  v_add_u32 v10, 2, v6
  v_xor_b32 v10, v10, v5
  v_or_b32 v9, v9, v10
  v_lshlrev_b32 v9, 4, v9
  v_add_u32 v9, v9, v8
  v_add_u32 v21, 8192, v9
  v_add_u32 v29, 73728, v9
  v_xor_b32 v9, 3, v4
  v_lshlrev_b32 v9, 2, v9
  v_add_u32 v10, 0, v6
  v_xor_b32 v10, v10, v5
  v_or_b32 v9, v9, v10
  v_lshlrev_b32 v9, 4, v9
  v_add_u32 v9, v9, v8
  v_add_u32 v22, 0, v9
  v_add_u32 v30, 65536, v9
  v_xor_b32 v9, 3, v4
  v_lshlrev_b32 v9, 2, v9
  v_add_u32 v10, 2, v6
  v_xor_b32 v10, v10, v5
  v_or_b32 v9, v9, v10
  v_lshlrev_b32 v9, 4, v9
  v_add_u32 v9, v9, v8
  v_add_u32 v23, 8192, v9
  v_add_u32 v31, 73728, v9
  v_mov_b32 v192, 0
  v_mov_b32 v193, 0
  v_mov_b32 v194, 0
  v_mov_b32 v195, 0
  v_mov_b32 v196, 0
  v_mov_b32 v197, 0
  v_mov_b32 v198, 0
  v_mov_b32 v199, 0
  v_mov_b32 v200, 0
  v_mov_b32 v201, 0
  v_mov_b32 v202, 0
  v_mov_b32 v203, 0
  v_mov_b32 v204, 0
  v_mov_b32 v205, 0
  v_mov_b32 v206, 0
  v_mov_b32 v207, 0
  v_mov_b32 v208, 0
  v_mov_b32 v209, 0
  v_mov_b32 v210, 0
  v_mov_b32 v211, 0
  v_mov_b32 v212, 0
  v_mov_b32 v213, 0
  v_mov_b32 v214, 0
  v_mov_b32 v215, 0
  v_mov_b32 v216, 0
  v_mov_b32 v217, 0
  v_mov_b32 v218, 0
  v_mov_b32 v219, 0
  v_mov_b32 v220, 0
  v_mov_b32 v221, 0
  v_mov_b32 v222, 0
  v_mov_b32 v223, 0
  v_mov_b32 v224, 0
  v_mov_b32 v225, 0
  v_mov_b32 v226, 0
  v_mov_b32 v227, 0
  v_mov_b32 v228, 0
  v_mov_b32 v229, 0
  v_mov_b32 v230, 0
  v_mov_b32 v231, 0
  v_mov_b32 v232, 0
  v_mov_b32 v233, 0
  v_mov_b32 v234, 0
  v_mov_b32 v235, 0
  v_mov_b32 v236, 0
  v_mov_b32 v237, 0
  v_mov_b32 v238, 0
  v_mov_b32 v239, 0
  v_mov_b32 v240, 0
  v_mov_b32 v241, 0
  v_mov_b32 v242, 0
  v_mov_b32 v243, 0
  v_mov_b32 v244, 0
  v_mov_b32 v245, 0
  v_mov_b32 v246, 0
  v_mov_b32 v247, 0
  v_mov_b32 v248, 0
  v_mov_b32 v249, 0
  v_mov_b32 v250, 0
  v_mov_b32 v251, 0
  v_mov_b32 v252, 0
  v_mov_b32 v253, 0
  v_mov_b32 v254, 0
  v_mov_b32 v255, 0
  ds_read_b64_tr_b16 v[96:97], v16 offset:0
  ds_read_b64_tr_b16 v[98:99], v17 offset:0
  ds_read_b64_tr_b16 v[100:101], v18 offset:0
  ds_read_b64_tr_b16 v[102:103], v19 offset:0
  ds_read_b64_tr_b16 v[104:105], v20 offset:0
  ds_read_b64_tr_b16 v[106:107], v21 offset:0
  ds_read_b64_tr_b16 v[108:109], v22 offset:0
  ds_read_b64_tr_b16 v[110:111], v23 offset:0
  s_waitcnt lgkmcnt(6)
  v_mfma_f32_32x32x16_bf16 v[192:207], v[96:99], v[128:131], v[192:207]
  ds_read_b64_tr_b16 v[96:97], v16 offset:16384
  ds_read_b64_tr_b16 v[98:99], v17 offset:16384
  s_waitcnt lgkmcnt(6)
  v_mfma_f32_32x32x16_bf16 v[208:223], v[100:103], v[128:131], v[208:223]
  ds_read_b64_tr_b16 v[100:101], v18 offset:16384
  ds_read_b64_tr_b16 v[102:103], v19 offset:16384
  s_waitcnt lgkmcnt(6)
  v_mfma_f32_32x32x16_bf16 v[224:239], v[104:107], v[128:131], v[224:239]
  ds_read_b64_tr_b16 v[104:105], v20 offset:16384
  ds_read_b64_tr_b16 v[106:107], v21 offset:16384
  s_waitcnt lgkmcnt(6)
  v_mfma_f32_32x32x16_bf16 v[240:255], v[108:111], v[128:131], v[240:255]
  ds_read_b64_tr_b16 v[108:109], v22 offset:16384
  ds_read_b64_tr_b16 v[110:111], v23 offset:16384
  s_waitcnt lgkmcnt(6)
  v_mfma_f32_32x32x16_bf16 v[192:207], v[96:99], v[132:135], v[192:207]
  ds_read_b64_tr_b16 v[96:97], v16 offset:32768
  ds_read_b64_tr_b16 v[98:99], v17 offset:32768
  s_waitcnt lgkmcnt(6)
  v_mfma_f32_32x32x16_bf16 v[208:223], v[100:103], v[132:135], v[208:223]
  ds_read_b64_tr_b16 v[100:101], v18 offset:32768
  ds_read_b64_tr_b16 v[102:103], v19 offset:32768
  s_waitcnt lgkmcnt(6)
  v_mfma_f32_32x32x16_bf16 v[224:239], v[104:107], v[132:135], v[224:239]
  ds_read_b64_tr_b16 v[104:105], v20 offset:32768
  ds_read_b64_tr_b16 v[106:107], v21 offset:32768
  s_waitcnt lgkmcnt(6)
  v_mfma_f32_32x32x16_bf16 v[240:255], v[108:111], v[132:135], v[240:255]
  ds_read_b64_tr_b16 v[108:109], v22 offset:32768
  ds_read_b64_tr_b16 v[110:111], v23 offset:32768
  s_waitcnt lgkmcnt(6)
  v_mfma_f32_32x32x16_bf16 v[192:207], v[96:99], v[136:139], v[192:207]
  ds_read_b64_tr_b16 v[96:97], v16 offset:49152
  ds_read_b64_tr_b16 v[98:99], v17 offset:49152
  s_waitcnt lgkmcnt(6)
  v_mfma_f32_32x32x16_bf16 v[208:223], v[100:103], v[136:139], v[208:223]
  ds_read_b64_tr_b16 v[100:101], v18 offset:49152
  ds_read_b64_tr_b16 v[102:103], v19 offset:49152
  s_waitcnt lgkmcnt(6)
  v_mfma_f32_32x32x16_bf16 v[224:239], v[104:107], v[136:139], v[224:239]
  ds_read_b64_tr_b16 v[104:105], v20 offset:49152
  ds_read_b64_tr_b16 v[106:107], v21 offset:49152
  s_waitcnt lgkmcnt(6)
  v_mfma_f32_32x32x16_bf16 v[240:255], v[108:111], v[136:139], v[240:255]
  ds_read_b64_tr_b16 v[108:109], v22 offset:49152
  ds_read_b64_tr_b16 v[110:111], v23 offset:49152
  s_waitcnt lgkmcnt(6)
  v_mfma_f32_32x32x16_bf16 v[192:207], v[96:99], v[140:143], v[192:207]
  ds_read_b64_tr_b16 v[96:97], v24 offset:0
  ds_read_b64_tr_b16 v[98:99], v25 offset:0
  s_waitcnt lgkmcnt(6)
  v_mfma_f32_32x32x16_bf16 v[208:223], v[100:103], v[140:143], v[208:223]
  ds_read_b64_tr_b16 v[100:101], v26 offset:0
  ds_read_b64_tr_b16 v[102:103], v27 offset:0
  s_waitcnt lgkmcnt(6)
  v_mfma_f32_32x32x16_bf16 v[224:239], v[104:107], v[140:143], v[224:239]
  ds_read_b64_tr_b16 v[104:105], v28 offset:0
  ds_read_b64_tr_b16 v[106:107], v29 offset:0
  s_waitcnt lgkmcnt(6)
  v_mfma_f32_32x32x16_bf16 v[240:255], v[108:111], v[140:143], v[240:255]
  ds_read_b64_tr_b16 v[108:109], v30 offset:0
  ds_read_b64_tr_b16 v[110:111], v31 offset:0
  s_waitcnt lgkmcnt(6)
  v_mfma_f32_32x32x16_bf16 v[192:207], v[96:99], v[144:147], v[192:207]
  ds_read_b64_tr_b16 v[96:97], v24 offset:16384
  ds_read_b64_tr_b16 v[98:99], v25 offset:16384
  s_waitcnt lgkmcnt(6)
  v_mfma_f32_32x32x16_bf16 v[208:223], v[100:103], v[144:147], v[208:223]
  ds_read_b64_tr_b16 v[100:101], v26 offset:16384
  ds_read_b64_tr_b16 v[102:103], v27 offset:16384
  s_waitcnt lgkmcnt(6)
  v_mfma_f32_32x32x16_bf16 v[224:239], v[104:107], v[144:147], v[224:239]
  ds_read_b64_tr_b16 v[104:105], v28 offset:16384
  ds_read_b64_tr_b16 v[106:107], v29 offset:16384
  s_waitcnt lgkmcnt(6)
  v_mfma_f32_32x32x16_bf16 v[240:255], v[108:111], v[144:147], v[240:255]
  ds_read_b64_tr_b16 v[108:109], v30 offset:16384
  ds_read_b64_tr_b16 v[110:111], v31 offset:16384
  s_waitcnt lgkmcnt(6)
  v_mfma_f32_32x32x16_bf16 v[192:207], v[96:99], v[148:151], v[192:207]
  ds_read_b64_tr_b16 v[96:97], v24 offset:32768
  ds_read_b64_tr_b16 v[98:99], v25 offset:32768
  s_waitcnt lgkmcnt(6)
  v_mfma_f32_32x32x16_bf16 v[208:223], v[100:103], v[148:151], v[208:223]
  ds_read_b64_tr_b16 v[100:101], v26 offset:32768
  ds_read_b64_tr_b16 v[102:103], v27 offset:32768
  s_waitcnt lgkmcnt(6)
  v_mfma_f32_32x32x16_bf16 v[224:239], v[104:107], v[148:151], v[224:239]
  ds_read_b64_tr_b16 v[104:105], v28 offset:32768
  ds_read_b64_tr_b16 v[106:107], v29 offset:32768
  s_waitcnt lgkmcnt(6)
  v_mfma_f32_32x32x16_bf16 v[240:255], v[108:111], v[148:151], v[240:255]
  ds_read_b64_tr_b16 v[108:109], v30 offset:32768
  ds_read_b64_tr_b16 v[110:111], v31 offset:32768
  s_waitcnt lgkmcnt(6)
  v_mfma_f32_32x32x16_bf16 v[192:207], v[96:99], v[152:155], v[192:207]
  ds_read_b64_tr_b16 v[96:97], v24 offset:49152
  ds_read_b64_tr_b16 v[98:99], v25 offset:49152
  s_waitcnt lgkmcnt(6)
  v_mfma_f32_32x32x16_bf16 v[208:223], v[100:103], v[152:155], v[208:223]
  ds_read_b64_tr_b16 v[100:101], v26 offset:49152
  ds_read_b64_tr_b16 v[102:103], v27 offset:49152
  s_waitcnt lgkmcnt(6)
  v_mfma_f32_32x32x16_bf16 v[224:239], v[104:107], v[152:155], v[224:239]
  ds_read_b64_tr_b16 v[104:105], v28 offset:49152
  ds_read_b64_tr_b16 v[106:107], v29 offset:49152
  s_waitcnt lgkmcnt(6)
  v_mfma_f32_32x32x16_bf16 v[240:255], v[108:111], v[152:155], v[240:255]
  ds_read_b64_tr_b16 v[108:109], v30 offset:49152
  ds_read_b64_tr_b16 v[110:111], v31 offset:49152
  s_waitcnt lgkmcnt(6)
  v_mfma_f32_32x32x16_bf16 v[192:207], v[96:99], v[156:159], v[192:207]
  s_waitcnt lgkmcnt(4)
  v_mfma_f32_32x32x16_bf16 v[208:223], v[100:103], v[156:159], v[208:223]
  s_waitcnt lgkmcnt(2)
  v_mfma_f32_32x32x16_bf16 v[224:239], v[104:107], v[156:159], v[224:239]
  s_waitcnt lgkmcnt(0)
  v_mfma_f32_32x32x16_bf16 v[240:255], v[108:111], v[156:159], v[240:255]
  s_barrier
  s_nop 11
  v_and_b32 v4, 31, v1
  v_mov_b32 v5, 1040
  v_mul_lo_u32 v4, v4, v5
  v_lshlrev_b32 v5, 3, v6
  v_add_u32 v4, v4, v5
  s_lshl_b32 s40, s33, 8
  v_add_u32 v4, s40, v4
  v_cvt_pk_bf16_f32 v8, v192, v193
  v_cvt_pk_bf16_f32 v9, v194, v195
  ds_write_b64 v4, v[8:9] offset:0
  v_cvt_pk_bf16_f32 v10, v196, v197
  v_cvt_pk_bf16_f32 v11, v198, v199
  ds_write_b64 v4, v[10:11] offset:16
  v_cvt_pk_bf16_f32 v8, v200, v201
  v_cvt_pk_bf16_f32 v9, v202, v203
  ds_write_b64 v4, v[8:9] offset:32
  v_cvt_pk_bf16_f32 v10, v204, v205
  v_cvt_pk_bf16_f32 v11, v206, v207
  ds_write_b64 v4, v[10:11] offset:48
  v_cvt_pk_bf16_f32 v8, v208, v209
  v_cvt_pk_bf16_f32 v9, v210, v211
  ds_write_b64 v4, v[8:9] offset:64
  v_cvt_pk_bf16_f32 v10, v212, v213
  v_cvt_pk_bf16_f32 v11, v214, v215
  ds_write_b64 v4, v[10:11] offset:80
  v_cvt_pk_bf16_f32 v8, v216, v217
  v_cvt_pk_bf16_f32 v9, v218, v219
  ds_write_b64 v4, v[8:9] offset:96
  v_cvt_pk_bf16_f32 v10, v220, v221
  v_cvt_pk_bf16_f32 v11, v222, v223
  ds_write_b64 v4, v[10:11] offset:112
  v_cvt_pk_bf16_f32 v8, v224, v225
  v_cvt_pk_bf16_f32 v9, v226, v227
  ds_write_b64 v4, v[8:9] offset:128
  v_cvt_pk_bf16_f32 v10, v228, v229
  v_cvt_pk_bf16_f32 v11, v230, v231
  ds_write_b64 v4, v[10:11] offset:144
  v_cvt_pk_bf16_f32 v8, v232, v233
  v_cvt_pk_bf16_f32 v9, v234, v235
  ds_write_b64 v4, v[8:9] offset:160
  v_cvt_pk_bf16_f32 v10, v236, v237
  v_cvt_pk_bf16_f32 v11, v238, v239
  ds_write_b64 v4, v[10:11] offset:176
  v_cvt_pk_bf16_f32 v8, v240, v241
  v_cvt_pk_bf16_f32 v9, v242, v243
  ds_write_b64 v4, v[8:9] offset:192
  v_cvt_pk_bf16_f32 v10, v244, v245
  v_cvt_pk_bf16_f32 v11, v246, v247
  ds_write_b64 v4, v[10:11] offset:208
  v_cvt_pk_bf16_f32 v8, v248, v249
  v_cvt_pk_bf16_f32 v9, v250, v251
  ds_write_b64 v4, v[8:9] offset:224
  v_cvt_pk_bf16_f32 v10, v252, v253
  v_cvt_pk_bf16_f32 v11, v254, v255
  ds_write_b64 v4, v[10:11] offset:240
  s_waitcnt lgkmcnt(0)
  s_barrier
  s_mul_i32 s40, s33, 8320
  v_lshlrev_b32 v4, 4, v1
  v_add_u32 v5, s40, v4
  ds_read_b128 v[64:67], v5 offset:0
  ds_read_b128 v[68:71], v5 offset:1040
  ds_read_b128 v[72:75], v5 offset:2080
  ds_read_b128 v[76:79], v5 offset:3120
  ds_read_b128 v[80:83], v5 offset:4160
  ds_read_b128 v[84:87], v5 offset:5200
  ds_read_b128 v[88:91], v5 offset:6240
  ds_read_b128 v[92:95], v5 offset:7280
  s_lshl_b32 s40, s50, 21
  s_lshl_b32 s41, s33, 19
  s_add_u32 s40, s40, s41
  s_lshl_b32 s41, s51, 10
  s_add_u32 s40, s40, s41
  s_add_u32 s40, s40, 1310720
  v_add_u32 v4, s40, v4
  s_waitcnt lgkmcnt(7)
  v_min_u32 v64, -2, v64
  v_min_u32 v65, -2, v65
  v_min_u32 v66, -2, v66
  v_min_u32 v67, -2, v67
  global_store_dwordx4 v4, v[64:67], s[30:31] sc1
  v_add_u32 v4, 0x10000, v4
  s_waitcnt lgkmcnt(6)
  v_min_u32 v68, -2, v68
  v_min_u32 v69, -2, v69
  v_min_u32 v70, -2, v70
  v_min_u32 v71, -2, v71
  global_store_dwordx4 v4, v[68:71], s[30:31] sc1
  v_add_u32 v4, 0x10000, v4
  s_waitcnt lgkmcnt(5)
  v_min_u32 v72, -2, v72
  v_min_u32 v73, -2, v73
  v_min_u32 v74, -2, v74
  v_min_u32 v75, -2, v75
  global_store_dwordx4 v4, v[72:75], s[30:31] sc1
  v_add_u32 v4, 0x10000, v4
  s_waitcnt lgkmcnt(4)
  v_min_u32 v76, -2, v76
  v_min_u32 v77, -2, v77
  v_min_u32 v78, -2, v78
  v_min_u32 v79, -2, v79
  global_store_dwordx4 v4, v[76:79], s[30:31] sc1
  v_add_u32 v4, 0x10000, v4
  s_waitcnt lgkmcnt(3)
  v_min_u32 v80, -2, v80
  v_min_u32 v81, -2, v81
  v_min_u32 v82, -2, v82
  v_min_u32 v83, -2, v83
  global_store_dwordx4 v4, v[80:83], s[30:31] sc1
  v_add_u32 v4, 0x10000, v4
  s_waitcnt lgkmcnt(2)
  v_min_u32 v84, -2, v84
  v_min_u32 v85, -2, v85
  v_min_u32 v86, -2, v86
  v_min_u32 v87, -2, v87
  global_store_dwordx4 v4, v[84:87], s[30:31] sc1
  v_add_u32 v4, 0x10000, v4
  s_waitcnt lgkmcnt(1)
  v_min_u32 v88, -2, v88
  v_min_u32 v89, -2, v89
  v_min_u32 v90, -2, v90
  v_min_u32 v91, -2, v91
  global_store_dwordx4 v4, v[88:91], s[30:31] sc1
  v_add_u32 v4, 0x10000, v4
  s_waitcnt lgkmcnt(0)
  v_min_u32 v92, -2, v92
  v_min_u32 v93, -2, v93
  v_min_u32 v94, -2, v94
  v_min_u32 v95, -2, v95
  global_store_dwordx4 v4, v[92:95], s[30:31] sc1
  s_waitcnt vmcnt(0)
  s_barrier
  s_cmp_lg_u32 s33, 0
  s_cbranch_scc1 Lst_17
  s_lshl_b32 s40, s50, 14
  s_lshl_b32 s41, s51, 3
  s_add_u32 s40, s40, s41
  s_add_u32 s40, s40, 65536
  v_and_b32 v10, 31, v1
  v_lshlrev_b32 v10, 9, v10
  v_add_u32 v10, s40, v10
  v_cmp_gt_u32 vcc, 32, v1
  s_and_saveexec_b64 s[48:49], vcc
  global_store_dwordx2 v10, v[2:3], s[30:31] sc1
  s_mov_b64 exec, s[48:49]
Lst_17:
  s_cmp_ge_u32 s52, 32
  s_cbranch_scc1 k_end2
  s_barrier
  s_lshl_b32 s40, s33, 15
  s_lshl_b32 s41, s52, 7
  s_add_u32 s40, s40, s41
  s_add_u32 s40, s40, 262144
  v_lshrrev_b32 v12, 3, v1
  v_lshlrev_b32 v12, 12, v12
  v_and_b32 v13, 7, v1
  v_lshlrev_b32 v13, 4, v13
  v_add_u32 v12, v12, v13
  v_add_u32 v12, s40, v12
  v_mov_b32 v92, 0
  v_mov_b32 v93, 0
  v_mov_b32 v94, 0
  v_mov_b32 v95, 0
  v_lshrrev_b32 v10, 3, v1
  v_lshlrev_b32 v10, 17, v10
  v_and_b32 v11, 7, v1
  v_lshlrev_b32 v11, 12, v11
  v_add_u32 v10, v10, v11
  v_add_u32 v10, s40, v10
  s_cmp_lt_u32 s33, 2
  s_cselect_b32 s41, 64, 56
  v_cmp_gt_u32 vcc, s41, v1
  s_and_saveexec_b64 s[48:49], vcc
  s_mov_b32 s38, 200000
Llp_18:
  global_load_dword v4, v10, s[30:31] sc1
  s_waitcnt vmcnt(0)
  v_cmp_eq_u32 vcc, -1, v4
  s_cbranch_vccz Llpd_19
  s_sub_u32 s38, s38, 1
  s_cmp_eq_u32 s38, 0
  s_cbranch_scc1 Llpd_19
  s_sleep 2
  s_branch Llp_18
Llpd_19:
  s_mov_b64 exec, s[48:49]
  s_mov_b32 s38, 200000
Lp_20:
  v_mov_b32 v10, v12
  global_load_dwordx4 v[64:67], v10, s[30:31] sc1
  v_add_u32 v10, 0x20000, v10
  global_load_dwordx4 v[68:71], v10, s[30:31] sc1
  v_add_u32 v10, 0x20000, v10
  global_load_dwordx4 v[72:75], v10, s[30:31] sc1
  v_add_u32 v10, 0x20000, v10
  global_load_dwordx4 v[76:79], v10, s[30:31] sc1
  v_add_u32 v10, 0x20000, v10
  global_load_dwordx4 v[80:83], v10, s[30:31] sc1
  v_add_u32 v10, 0x20000, v10
  global_load_dwordx4 v[84:87], v10, s[30:31] sc1
  v_add_u32 v10, 0x20000, v10
  global_load_dwordx4 v[88:91], v10, s[30:31] sc1
  v_add_u32 v10, 0x20000, v10
  s_cmp_ge_u32 s33, 2
  s_cbranch_scc1 Lf7_22
  global_load_dwordx4 v[92:95], v10, s[30:31] sc1
Lf7_22:
  s_waitcnt vmcnt(0)
  v_max_u32 v4, v64, v65
  v_max3_u32 v4, v4, v66, v67
  v_max3_u32 v4, v4, v68, v69
  v_max3_u32 v4, v4, v70, v71
  v_max3_u32 v4, v4, v72, v73
  v_max3_u32 v4, v4, v74, v75
  v_max3_u32 v4, v4, v76, v77
  v_max3_u32 v4, v4, v78, v79
  v_max3_u32 v4, v4, v80, v81
  v_max3_u32 v4, v4, v82, v83
  v_max3_u32 v4, v4, v84, v85
  v_max3_u32 v4, v4, v86, v87
  v_max3_u32 v4, v4, v88, v89
  v_max3_u32 v4, v4, v90, v91
  v_max3_u32 v4, v4, v92, v93
  v_max3_u32 v4, v4, v94, v95
  v_cmp_eq_u32 vcc, -1, v4
  s_cbranch_vccz Lpd_21
  s_sub_u32 s38, s38, 1
  s_cmp_eq_u32 s38, 0
  s_cbranch_scc1 Lpd_21
  s_sleep 1
  s_branch Lp_20
Lpd_21:
  v_add_f32 v64, v64, v68
  v_add_f32 v72, v72, v76
  v_add_f32 v80, v80, v84
  v_add_f32 v88, v88, v92
  v_add_f32 v65, v65, v69
  v_add_f32 v73, v73, v77
  v_add_f32 v81, v81, v85
  v_add_f32 v89, v89, v93
  v_add_f32 v66, v66, v70
  v_add_f32 v74, v74, v78
  v_add_f32 v82, v82, v86
  v_add_f32 v90, v90, v94
  v_add_f32 v67, v67, v71
  v_add_f32 v75, v75, v79
  v_add_f32 v83, v83, v87
  v_add_f32 v91, v91, v95
  v_add_f32 v64, v64, v72
  v_add_f32 v68, v80, v88
  v_add_f32 v65, v65, v73
  v_add_f32 v69, v81, v89
  v_add_f32 v66, v66, v74
  v_add_f32 v70, v82, v90
  v_add_f32 v67, v67, v75
  v_add_f32 v71, v83, v91
  s_lshl_b32 s40, s33, 10
  v_lshrrev_b32 v10, 3, v1
  v_lshlrev_b32 v10, 7, v10
  v_add_u32 v10, v10, v13
  v_add_u32 v10, s40, v10
  ds_write_b128 v10, v[64:67] offset:0
  ds_write_b128 v10, v[68:71] offset:4096
  s_waitcnt lgkmcnt(0)
  s_barrier
  s_cmp_lg_u32 s33, 0
  s_cbranch_scc1 Lfin_23
  v_lshrrev_b32 v10, 5, v1
  v_lshlrev_b32 v10, 12, v10
  v_and_b32 v11, 31, v1
  v_lshlrev_b32 v11, 2, v11
  v_add_u32 v10, v10, v11
  ds_read_b32 v64, v10 offset:0
  ds_read_b32 v65, v10 offset:128
  ds_read_b32 v66, v10 offset:256
  ds_read_b32 v67, v10 offset:384
  ds_read_b32 v68, v10 offset:512
  ds_read_b32 v69, v10 offset:640
  ds_read_b32 v70, v10 offset:768
  ds_read_b32 v71, v10 offset:896
  ds_read_b32 v72, v10 offset:1024
  ds_read_b32 v73, v10 offset:1152
  ds_read_b32 v74, v10 offset:1280
  ds_read_b32 v75, v10 offset:1408
  ds_read_b32 v76, v10 offset:1536
  ds_read_b32 v77, v10 offset:1664
  ds_read_b32 v78, v10 offset:1792
  ds_read_b32 v79, v10 offset:1920
  ds_read_b32 v80, v10 offset:2048
  ds_read_b32 v81, v10 offset:2176
  ds_read_b32 v82, v10 offset:2304
  ds_read_b32 v83, v10 offset:2432
  ds_read_b32 v84, v10 offset:2560
  ds_read_b32 v85, v10 offset:2688
  ds_read_b32 v86, v10 offset:2816
  ds_read_b32 v87, v10 offset:2944
  ds_read_b32 v88, v10 offset:3072
  ds_read_b32 v89, v10 offset:3200
  ds_read_b32 v90, v10 offset:3328
  ds_read_b32 v91, v10 offset:3456
  ds_read_b32 v92, v10 offset:3584
  ds_read_b32 v93, v10 offset:3712
  ds_read_b32 v94, v10 offset:3840
  ds_read_b32 v95, v10 offset:3968
  s_waitcnt lgkmcnt(0)
  v_add_f32 v64, v64, v80
  v_add_f32 v65, v65, v81
  v_add_f32 v66, v66, v82
  v_add_f32 v67, v67, v83
  v_add_f32 v68, v68, v84
  v_add_f32 v69, v69, v85
  v_add_f32 v70, v70, v86
  v_add_f32 v71, v71, v87
  v_add_f32 v72, v72, v88
  v_add_f32 v73, v73, v89
  v_add_f32 v74, v74, v90
  v_add_f32 v75, v75, v91
  v_add_f32 v76, v76, v92
  v_add_f32 v77, v77, v93
  v_add_f32 v78, v78, v94
  v_add_f32 v79, v79, v95
  v_add_f32 v64, v64, v72
  v_add_f32 v65, v65, v73
  v_add_f32 v66, v66, v74
  v_add_f32 v67, v67, v75
  v_add_f32 v68, v68, v76
  v_add_f32 v69, v69, v77
  v_add_f32 v70, v70, v78
  v_add_f32 v71, v71, v79
  v_add_f32 v64, v64, v68
  v_add_f32 v65, v65, v69
  v_add_f32 v66, v66, v70
  v_add_f32 v67, v67, v71
  v_add_f32 v64, v64, v66
  v_add_f32 v65, v65, v67
  v_add_f32 v64, v64, v65
  v_mov_b32 v248, s60
  v_sub_f32 v5, 1.0, v248
  v_cmp_gt_u32 vcc, 32, v1
  s_nop 1
  v_cndmask_b32 v5, v5, v248, vcc
  v_mul_f32 v64, v64, v5
  v_mov_b32 v65, v64
  s_nop 1
  v_permlane32_swap_b32 v64, v65
  s_nop 1
  v_add_f32 v64, v64, v65
  s_nop 1
  v_mov_b32_dpp v65, v64 quad_perm:[1,0,3,2] row_mask:0xf bank_mask:0xf
  v_cvt_pk_bf16_f32 v64, v64, v65
  s_lshl_b32 s40, s52, 6
  v_lshrrev_b32 v10, 1, v1
  v_lshlrev_b32 v10, 2, v10
  v_add_u32 v10, s40, v10
  v_and_b32 v11, 33, v1
  v_cmp_eq_u32 vcc, 0, v11
  s_and_saveexec_b64 s[48:49], vcc
  global_store_dword v10, v64, s[26:27]
  s_mov_b64 exec, s[48:49]
Lfin_23:
k_end2:
k_end:
  s_endpgm
.section .rodata,"a"
.p2align 6
.amdhsa_kernel gated_mix__compressed_kv_cla__geglu_ffn__decode_kernel
  .amdhsa_next_free_vgpr 256
  .amdhsa_next_free_sgpr 102
  .amdhsa_accum_offset 256
  .amdhsa_group_segment_fixed_size 0
  .amdhsa_kernarg_size 112
  .amdhsa_user_sgpr_count 2
  .amdhsa_user_sgpr_kernarg_segment_ptr 1
  .amdhsa_system_sgpr_workgroup_id_x 1
.end_amdhsa_kernel
```
